```python
import torch

def _softmax(x, axis=-1):
    return torch.softmax(x, dim=axis)

def _gelu(x):
    return torch.nn.functional.gelu(x, approximate='tanh')

def _silu(x):
    return torch.nn.functional.silu(x)

def _sigmoid(x):
    return torch.sigmoid(x)

def _layernorm(x, axis=-1, eps=1e-05):
    m = x.mean(dim=axis, keepdim=True)
    v = x.var(dim=axis, keepdim=True, unbiased=False)
    return (x - m) / torch.sqrt(v + eps)

def _scatter_add(tgt, idx, src, axis=0):
    return tgt.clone().index_add_(axis, idx, src)

def _segment_sum(src, seg, n):
    out = torch.zeros((n,) + src.shape[1:], dtype=src.dtype)
    return out.index_add_(0, seg, src)

def _pad(x, pw):
    flat = tuple((v for pair in reversed(pw) for v in pair))
    return torch.nn.functional.pad(x, flat)
kernel_name = 'standalone__dit_adaln_block__diffusion'

def setup_inputs():

    _w = lambda a: (lambda t: t.to(torch.bfloat16) if t.is_floating_point() else t)(torch.as_tensor(a))
    B, N, D = (2, 256, 1152)
    return {'x': _w((lambda *s: torch.randn(*s, dtype=torch.bfloat16) * 0.05)(B, N, D)), 'c': _w((lambda *s: torch.randn(*s, dtype=torch.bfloat16) * 0.2)(B, D)), 'wqkv': _w((lambda *s: torch.randn(*s, dtype=torch.bfloat16) * 0.05)(D, 3 * D)), 'wo': _w((lambda *s: torch.randn(*s, dtype=torch.bfloat16) * 0.05)(D, D)), 'w_mod': _w((lambda *s: torch.randn(*s, dtype=torch.bfloat16) * 0.2)(D, 6 * D))}

def reference(x, c, wqkv, wo, w_mod):
    B, N, D = x.shape
    mod = (_silu(c) @ w_mod).reshape(B, 6, 1, D)
    shift_a, scale_a, gate_a, shift_m, scale_m, gate_m = [mod[:, i] for i in range(6)]
    h = _layernorm(x, axis=-1) * (1 + scale_a) + shift_a
    qkv = h @ wqkv
    q, k, v = (qkv[..., :D].clone(), qkv[..., D:2 * D].clone(), qkv[..., 2 * D:].clone())
    p = _softmax(torch.einsum('bqd,bkd->bqk', q, k) * D ** (-0.5), axis=-1)
    a = torch.einsum('bqk,bkd->bqd', p, v) @ wo
    return x + gate_a * a
```

```asm
; @launch grid=(256,1,1) block=(512,1,1) lds=161408
.amdgcn_target "amdgcn-amd-amdhsa--gfx950"
.text
.p2align 8
.globl standalone__dit_adaln_block__diffusion_kernel
.type standalone__dit_adaln_block__diffusion_kernel,@function
standalone__dit_adaln_block__diffusion_kernel:
    s_cmp_ge_u32 s2, 256
    s_cbranch_scc1 L_end
    s_getpc_b64 s[62:63]
L_pc:
    s_lshl_b32 s60, s2, 7
    s_and_b32 s60, s60, 0x7c00
    v_cmp_gt_u32 vcc, 16, v0
    v_lshl_add_u32 v8, v0, 6, s60
    v_min_u32 v8, L_end-L_pc, v8
    v_mov_b32 v9, s63
    s_and_saveexec_b64 s[64:65], vcc
    s_cbranch_execz L_nocpf
    v_add_co_u32 v8, vcc, s62, v8
    s_nop 1
    v_addc_co_u32 v9, vcc, 0, v9, vcc
    global_load_dword v190, v[8:9], off
L_nocpf:
    s_mov_b64 exec, -1
    s_load_dwordx2 s[4:5], s[0:1], 0
    s_load_dwordx2 s[8:9], s[0:1], 8
    s_load_dwordx2 s[12:13], s[0:1], 16
    s_load_dwordx2 s[16:17], s[0:1], 24
    s_load_dwordx2 s[20:21], s[0:1], 32
    s_load_dwordx2 s[24:25], s[0:1], 40
    s_load_dwordx2 s[28:29], s[0:1], 48
    s_load_dwordx2 s[32:33], s[0:1], 56
    s_memrealtime s[58:59]
    v_lshrrev_b32 v1, 6, v0
    v_and_b32 v2, 63, v0
    v_readfirstlane_b32 s36, v1
    v_and_b32 v3, 15, v2
    v_lshrrev_b32 v4, 4, v2
    v_lshlrev_b32 v5, 4, v2
    v_lshlrev_b32 v6, 2, v3
    v_add_u32 v6, 160768, v6
    v_mov_b32 v7, 0
    ds_write_b32 v6, v7
    s_mov_b32 s6, 0x120000
    s_mov_b32 s7, 0x20000
    s_mov_b32 s10, 0x1200
    s_mov_b32 s11, 0x20000
    s_mov_b32 s14, 0x798000
    s_mov_b32 s15, 0x20000
    s_mov_b32 s18, 0x288000
    s_mov_b32 s19, 0x20000
    s_mov_b32 s22, 0xf30000
    s_mov_b32 s23, 0x20000
    s_mov_b32 s26, 0x120000
    s_mov_b32 s27, 0x20000
    s_mov_b32 s30, 0x100
    s_mov_b32 s31, 0x20000
    s_mov_b32 s34, 0x8f1800
    s_mov_b32 s35, 0x20000
    s_and_b32 s38, s2, 7
    s_lshr_b32 s39, s2, 3
    s_and_b32 s37, s36, 3
    s_mov_b32 s47, 0xffff0000
    s_mul_i32 s44, s38, 28
    s_mul_i32 s60, s38, 24
    s_add_u32 s60, s60, 24
    s_min_u32 s44, s44, s60
    s_add_u32 s44, s44, s39
    s_lshr_b32 s45, s44, 3
    s_and_b32 s46, s44, 7
    s_cmp_lt_u32 s38, 6
    s_cselect_b32 s99, 28, 24
    s_sub_u32 s60, s39, s99
    s_lshl_b32 s61, s38, 2
    s_lshl_b32 s62, s38, 3
    s_sub_u32 s62, s62, 24
    s_cmp_lt_u32 s38, 6
    s_cselect_b32 s61, s61, s62
    s_add_u32 s97, s60, s61
    s_add_u32 s60, s97, 108
    s_lshr_b32 s61, s44, 1
    s_bitcmp1_b32 s44, 0
    s_cselect_b32 s61, s61, 255
    s_cmp_ge_u32 s39, s99
    s_cselect_b32 s96, s60, s61
    s_mov_b32 s95, 0
    s_mov_b32 s94, 156672
    s_cmp_ge_u32 s96, 144
    s_cbranch_scc1 L_noslice
    s_cmp_lt_u32 s36, 4
    s_cbranch_scc1 L_gemv
    s_lshl_b32 s61, s96, 2
    s_add_u32 s61, s61, s37
    s_mul_i32 s62, s61, 2304
    v_lshlrev_b32 v8, 2, v2
    s_waitcnt lgkmcnt(0)
    buffer_load_dwordx4 v[12:15], v5, s[4:7], s62 offen
    buffer_load_dwordx4 v[16:19], v5, s[4:7], s62 offen offset:1024
    buffer_load_dword v20, v8, s[4:7], s62 offen offset:2048
    s_barrier
    s_cmp_ge_u32 s96, 128
    s_cbranch_scc1 L_hi_nobar
    s_lshl_b32 s61, s61, 7
    s_add_u32 s61, s61, 9089024
    s_mov_b32 s63, 0x3a638e39
    s_setprio 3
    s_waitcnt vmcnt(2)
    v_readfirstlane_b32 s64, v12
    s_nop 1
    s_lshl_b32 s64, s64, 16
    v_lshlrev_b32 v24, 16, v12
    v_and_b32 v25, s47, v12
    v_lshlrev_b32 v26, 16, v13
    v_and_b32 v27, s47, v13
    v_lshlrev_b32 v28, 16, v14
    v_and_b32 v29, s47, v14
    v_lshlrev_b32 v30, 16, v15
    v_and_b32 v31, s47, v15
    v_subrev_f32 v24, s64, v24
    v_subrev_f32 v25, s64, v25
    v_subrev_f32 v26, s64, v26
    v_subrev_f32 v27, s64, v27
    v_subrev_f32 v28, s64, v28
    v_subrev_f32 v29, s64, v29
    v_subrev_f32 v30, s64, v30
    v_subrev_f32 v31, s64, v31
    v_mov_b32 v44, v24
    v_mul_f32 v46, v24, v24
    v_mov_b32 v45, v25
    v_mul_f32 v47, v25, v25
    v_add_f32 v44, v44, v26
    v_fmac_f32 v46, v26, v26
    v_add_f32 v45, v45, v27
    v_fmac_f32 v47, v27, v27
    v_add_f32 v44, v44, v28
    v_fmac_f32 v46, v28, v28
    v_add_f32 v45, v45, v29
    v_fmac_f32 v47, v29, v29
    v_add_f32 v44, v44, v30
    v_fmac_f32 v46, v30, v30
    v_add_f32 v45, v45, v31
    v_fmac_f32 v47, v31, v31
    s_waitcnt vmcnt(0)
    v_lshlrev_b32 v32, 16, v16
    v_and_b32 v33, s47, v16
    v_lshlrev_b32 v34, 16, v17
    v_and_b32 v35, s47, v17
    v_lshlrev_b32 v36, 16, v18
    v_and_b32 v37, s47, v18
    v_lshlrev_b32 v38, 16, v19
    v_and_b32 v39, s47, v19
    v_lshlrev_b32 v40, 16, v20
    v_and_b32 v41, s47, v20
    v_subrev_f32 v32, s64, v32
    v_subrev_f32 v33, s64, v33
    v_subrev_f32 v34, s64, v34
    v_subrev_f32 v35, s64, v35
    v_subrev_f32 v36, s64, v36
    v_subrev_f32 v37, s64, v37
    v_subrev_f32 v38, s64, v38
    v_subrev_f32 v39, s64, v39
    v_subrev_f32 v40, s64, v40
    v_subrev_f32 v41, s64, v41
    v_add_f32 v44, v44, v32
    v_fmac_f32 v46, v32, v32
    v_add_f32 v45, v45, v33
    v_fmac_f32 v47, v33, v33
    v_add_f32 v44, v44, v34
    v_fmac_f32 v46, v34, v34
    v_add_f32 v45, v45, v35
    v_fmac_f32 v47, v35, v35
    v_add_f32 v44, v44, v36
    v_fmac_f32 v46, v36, v36
    v_add_f32 v45, v45, v37
    v_fmac_f32 v47, v37, v37
    v_add_f32 v44, v44, v38
    v_fmac_f32 v46, v38, v38
    v_add_f32 v45, v45, v39
    v_fmac_f32 v47, v39, v39
    v_add_f32 v44, v44, v40
    v_fmac_f32 v46, v40, v40
    v_add_f32 v45, v45, v41
    v_fmac_f32 v47, v41, v41
    v_add_f32 v44, v44, v45
    v_add_f32 v46, v46, v47
    s_nop 0
    v_add_f32_dpp v44, v44, v44 row_ror:1 row_mask:0xf bank_mask:0xf
    v_add_f32_dpp v46, v46, v46 row_ror:1 row_mask:0xf bank_mask:0xf
    s_nop 0
    v_add_f32_dpp v44, v44, v44 row_ror:2 row_mask:0xf bank_mask:0xf
    v_add_f32_dpp v46, v46, v46 row_ror:2 row_mask:0xf bank_mask:0xf
    s_nop 0
    v_add_f32_dpp v44, v44, v44 row_ror:4 row_mask:0xf bank_mask:0xf
    v_add_f32_dpp v46, v46, v46 row_ror:4 row_mask:0xf bank_mask:0xf
    s_nop 0
    v_add_f32_dpp v44, v44, v44 row_ror:8 row_mask:0xf bank_mask:0xf
    v_add_f32_dpp v46, v46, v46 row_ror:8 row_mask:0xf bank_mask:0xf
    v_mov_b32 v45, v44
    v_mov_b32 v47, v46
    s_nop 0
    v_permlane16_swap_b32 v44, v45
    v_permlane16_swap_b32 v46, v47
    v_add_f32 v44, v44, v45
    v_add_f32 v46, v46, v47
    v_mov_b32 v45, v44
    v_mov_b32 v47, v46
    s_nop 0
    v_permlane32_swap_b32 v44, v45
    v_permlane32_swap_b32 v46, v47
    v_add_f32 v44, v44, v45
    v_add_f32 v46, v46, v47
    v_mul_f32 v54, s63, v44
    v_mul_f32 v55, s63, v46
    v_fma_f32 v55, -v54, v54, v55
    v_max_f32 v55, 0, v55
    v_add_f32 v56, s64, v54
    v_cvt_pk_bf16_f32 v55, v55, v55
    v_lshlrev_b32 v55, 16, v55
    v_cvt_pk_bf16_f32 v56, v56, v56
    v_lshlrev_b32 v56, 16, v56
    v_add_f32 v55, 0x3727c5ac, v55
    v_sub_f32 v56, s64, v56
    v_cvt_pk_bf16_f32 v55, v55, v55
    v_lshlrev_b32 v55, 16, v55
    v_sqrt_f32 v55, v55
    s_nop 0
    v_cvt_pk_bf16_f32 v55, v55, v55
    v_lshlrev_b32 v55, 16, v55
    v_rcp_f32 v55, v55
    s_nop 0
    v_mul_f32 v56, v56, v55
    v_fma_f32 v24, v24, v55, v56
    v_fma_f32 v25, v25, v55, v56
    v_fma_f32 v26, v26, v55, v56
    v_fma_f32 v27, v27, v55, v56
    v_cvt_pk_f16_f32 v12, v24, v25
    v_fma_f32 v28, v28, v55, v56
    v_fma_f32 v29, v29, v55, v56
    v_cvt_pk_f16_f32 v13, v26, v27
    v_fma_f32 v30, v30, v55, v56
    v_fma_f32 v31, v31, v55, v56
    v_cvt_pk_f16_f32 v14, v28, v29
    v_fma_f32 v32, v32, v55, v56
    v_fma_f32 v33, v33, v55, v56
    v_cvt_pk_f16_f32 v15, v30, v31
    buffer_store_dwordx4 v[12:15], v5, s[32:35], s62 offen sc1
    v_fma_f32 v34, v34, v55, v56
    v_fma_f32 v35, v35, v55, v56
    v_cvt_pk_f16_f32 v16, v32, v33
    v_fma_f32 v36, v36, v55, v56
    v_fma_f32 v37, v37, v55, v56
    v_cvt_pk_f16_f32 v17, v34, v35
    v_fma_f32 v38, v38, v55, v56
    v_fma_f32 v39, v39, v55, v56
    v_cvt_pk_f16_f32 v18, v36, v37
    v_fma_f32 v40, v40, v55, v56
    v_fma_f32 v41, v41, v55, v56
    v_cvt_pk_f16_f32 v19, v38, v39
    v_cvt_pk_f16_f32 v20, v40, v41
    buffer_store_dwordx4 v[16:19], v5, s[32:35], s62 offen offset:1024 sc1
    buffer_store_dword v20, v8, s[32:35], s62 offen offset:2048 sc1
    v_mov_b32 v9, 0
    buffer_load_dword v10, v9, s[28:31], 0 offen sc0 sc1
    s_setprio 0
    s_branch L_hi
L_noslice:
    s_cmp_ge_u32 s36, 4
    s_cbranch_scc1 L_hi_noln
    s_lshl_b32 s60, s2, 3
    s_add_u32 s60, s60, s36
    s_cmp_lg_u32 s60, 1
    s_cbranch_scc1 L_nononce
    s_waitcnt lgkmcnt(0)
    s_mul_i32 s60, s58, 0x9E3779B1
    s_max_u32 s60, s60, 1
    v_mov_b32 v6, s60
    buffer_store_dword v6, v7, s[28:31], 0 offen sc0 sc1
L_nononce:
    s_cmp_lg_u32 s36, 2
    s_cbranch_scc1 L_nofp
    s_lshr_b32 s60, s44, 1
    s_lshl_b32 s60, s60, 12
    s_add_u32 s60, s60, 8945664
    v_lshlrev_b32 v8, 7, v2
    s_waitcnt lgkmcnt(0)
    s_mov_b32 exec_hi, 0
    buffer_load_dword v189, v8, s[32:35], s60 offen sc1
    s_lshr_b32 s60, s44, 1
    s_lshl_b32 s60, s60, 10
    s_add_u32 s60, s60, 1179648
    s_mov_b64 exec, 0xff
    buffer_load_dword v189, v8, s[32:35], s60 offen sc1
    s_lshr_b32 s60, s44, 1
    s_mul_i32 s60, s60, 2432
    s_add_u32 s60, s60, 8683520
    s_mov_b64 exec, 0x7ffff
    buffer_load_dword v189, v8, s[32:35], s60 offen sc1
    s_mov_b64 exec, -1
L_nofp:
    s_branch L_hi_noln
L_gemv:
    s_and_b32 s70, s96, 3
    s_lshr_b32 s71, s96, 2
    s_mul_i32 s60, s70, 288
    s_mul_i32 s61, s37, 72
    s_add_u32 s60, s60, s61
    s_lshl_b32 s61, s60, 1
    v_lshlrev_b32 v6, 2, v2
    v_lshrrev_b32 v7, 3, v2
    v_and_b32 v8, 7, v2
    v_mul_u32_u24 v9, 13824, v7
    v_lshl_add_u32 v9, v8, 4, v9
    s_mul_i32 s62, s60, 13824
    s_lshl_b32 s63, s71, 7
    s_add_u32 s62, s62, s63
    s_waitcnt lgkmcnt(0)
    buffer_load_dword v120, v6, s[8:11], s61 offen
    buffer_load_dword v121, v6, s[8:11], s61 offen offset:2304
    s_cmp_lg_u32 s95, 0
    s_cbranch_scc1 L_gemv_nobar
    s_barrier
L_gemv_nobar:
    buffer_load_dwordx4 v[44:47], v9, s[20:23], s62 offen nt
    s_add_u32 s62, s62, 110592
    buffer_load_dwordx4 v[48:51], v9, s[20:23], s62 offen nt
    s_add_u32 s62, s62, 110592
    buffer_load_dwordx4 v[52:55], v9, s[20:23], s62 offen nt
    s_add_u32 s62, s62, 110592
    buffer_load_dwordx4 v[56:59], v9, s[20:23], s62 offen nt
    s_add_u32 s62, s62, 110592
    buffer_load_dwordx4 v[60:63], v9, s[20:23], s62 offen nt
    s_add_u32 s62, s62, 110592
    buffer_load_dwordx4 v[64:67], v9, s[20:23], s62 offen nt
    s_add_u32 s62, s62, 110592
    buffer_load_dwordx4 v[68:71], v9, s[20:23], s62 offen nt
    s_add_u32 s62, s62, 110592
    buffer_load_dwordx4 v[72:75], v9, s[20:23], s62 offen nt
    s_add_u32 s62, s62, 110592
    buffer_load_dwordx4 v[76:79], v9, s[20:23], s62 offen nt
    v_mov_b32 v80, 0
    v_mov_b32 v81, 0
    v_mov_b32 v82, 0
    v_mov_b32 v83, 0
    v_mov_b32 v84, 0
    v_mov_b32 v85, 0
    v_mov_b32 v86, 0
    v_mov_b32 v87, 0
    v_mov_b32 v88, 0
    v_mov_b32 v89, 0
    v_mov_b32 v90, 0
    v_mov_b32 v91, 0
    v_mov_b32 v92, 0
    v_mov_b32 v93, 0
    v_mov_b32 v94, 0
    v_mov_b32 v95, 0
    s_mov_b32 s64, 0xbfb8aa3b
    s_lshl_b32 s65, s37, 9
    s_add_u32 s65, s65, s94
    s_add_u32 s65, s65, 2048
    v_lshl_add_u32 v10, v2, 3, s65
    v_lshl_add_u32 v11, v7, 2, s65
    s_and_b32 s49, s38, 4
    s_and_b32 s60, s39, 3
    s_add_u32 s49, s49, s60
    s_and_b32 s50, s38, 3
    s_mul_i32 s50, s50, 6
    s_lshr_b32 s60, s39, 2
    s_add_u32 s50, s50, s60
    s_lshr_b32 s51, s38, 2
    s_lshl_b32 s52, s51, 4
    s_and_b32 s60, s39, 15
    s_add_u32 s52, s52, s60
    s_and_b32 s53, s38, 3
    s_lshl_b32 s53, s53, 1
    s_lshr_b32 s60, s39, 4
    s_add_u32 s53, s53, s60
    s_and_b32 s60, s39, 3
    s_mul_i32 s60, s60, 2
    s_lshr_b32 s93, s39, 2
    s_mul_i32 s93, s93, 3
    s_add_u32 s60, s60, s93
    s_mul_i32 s92, s60, 7282
    s_lshr_b32 s92, s92, 16
    s_mul_i32 s93, s92, 9
    s_sub_u32 s93, s60, s93
    s_waitcnt vmcnt(9)
    v_lshlrev_b32 v122, 16, v120
    v_lshlrev_b32 v123, 16, v121
    v_and_b32 v124, s47, v120
    v_and_b32 v125, s47, v121
    v_mul_f32 v126, s64, v122
    v_mul_f32 v127, s64, v123
    v_mul_f32 v128, s64, v124
    v_mul_f32 v129, s64, v125
    v_exp_f32 v126, v126
    v_exp_f32 v127, v127
    v_exp_f32 v128, v128
    v_exp_f32 v129, v129
    v_add_f32 v126, 1.0, v126
    v_add_f32 v127, 1.0, v127
    v_add_f32 v128, 1.0, v128
    v_add_f32 v129, 1.0, v129
    v_rcp_f32 v126, v126
    v_rcp_f32 v127, v127
    v_rcp_f32 v128, v128
    v_rcp_f32 v129, v129
    v_mul_f32 v126, v126, v122
    v_mul_f32 v127, v127, v123
    v_mul_f32 v128, v128, v124
    v_mul_f32 v129, v129, v125
    v_cvt_pk_bf16_f32 v130, v126, v127
    v_cvt_pk_bf16_f32 v131, v128, v129
    ds_write_b64 v10, v[130:131]
    ds_read_b32 v120, v11 offset:0
    ds_read_b32 v121, v11 offset:32
    ds_read_b32 v122, v11 offset:64
    ds_read_b32 v123, v11 offset:96
    ds_read_b32 v124, v11 offset:128
    ds_read_b32 v125, v11 offset:160
    ds_read_b32 v126, v11 offset:192
    ds_read_b32 v127, v11 offset:224
    ds_read_b32 v128, v11 offset:256
    v_mov_b32 v12, 0
    buffer_load_dword v134, v12, s[28:31], 0 offen sc0 sc1
    v_lshrrev_b32 v14, 4, v2
    v_lshlrev_b32 v14, 7, v14
    v_lshl_add_u32 v14, v8, 4, v14
    v_add_u32 v14, s94, v14
    s_lshl_b32 s60, s37, 9
    v_add_u32 v10, s60, v14
    v_lshrrev_b32 v15, 5, v2
    v_mul_u32_u24 v15, 55296, v15
    v_lshl_add_u32 v15, v8, 5, v15
    v_and_b32 v16, 16, v2
    v_add_u32 v15, v15, v16
    s_mul_i32 s66, s70, 13824
    s_lshl_b32 s60, s71, 8
    s_add_u32 s66, s66, s60
    s_add_u32 s66, s66, 1179648
    v_mov_b32 v135, 0xff
    s_waitcnt lgkmcnt(0)
    v_lshlrev_b32 v96, 16, v120
    v_and_b32 v97, s47, v120
    v_lshlrev_b32 v98, 16, v121
    v_and_b32 v99, s47, v121
    v_lshlrev_b32 v100, 16, v122
    v_and_b32 v101, s47, v122
    v_lshlrev_b32 v102, 16, v123
    v_and_b32 v103, s47, v123
    v_lshlrev_b32 v104, 16, v124
    v_and_b32 v105, s47, v124
    v_lshlrev_b32 v106, 16, v125
    v_and_b32 v107, s47, v125
    v_lshlrev_b32 v108, 16, v126
    v_and_b32 v109, s47, v126
    v_lshlrev_b32 v110, 16, v127
    v_and_b32 v111, s47, v127
    v_lshlrev_b32 v112, 16, v128
    v_and_b32 v113, s47, v128
    s_waitcnt vmcnt(9)
    v_lshlrev_b32 v128, 16, v44
    v_and_b32 v129, s47, v44
    v_fmac_f32 v80, v128, v96
    v_fmac_f32 v81, v129, v96
    v_fmac_f32 v88, v128, v97
    v_fmac_f32 v89, v129, v97
    v_lshlrev_b32 v130, 16, v45
    v_and_b32 v131, s47, v45
    v_fmac_f32 v82, v130, v96
    v_fmac_f32 v83, v131, v96
    v_fmac_f32 v90, v130, v97
    v_fmac_f32 v91, v131, v97
    v_lshlrev_b32 v128, 16, v46
    v_and_b32 v129, s47, v46
    v_fmac_f32 v84, v128, v96
    v_fmac_f32 v85, v129, v96
    v_fmac_f32 v92, v128, v97
    v_fmac_f32 v93, v129, v97
    v_lshlrev_b32 v130, 16, v47
    v_and_b32 v131, s47, v47
    v_fmac_f32 v86, v130, v96
    v_fmac_f32 v87, v131, v96
    v_fmac_f32 v94, v130, v97
    v_fmac_f32 v95, v131, v97
    s_waitcnt vmcnt(8)
    v_lshlrev_b32 v128, 16, v48
    v_and_b32 v129, s47, v48
    v_fmac_f32 v80, v128, v98
    v_fmac_f32 v81, v129, v98
    v_fmac_f32 v88, v128, v99
    v_fmac_f32 v89, v129, v99
    v_lshlrev_b32 v130, 16, v49
    v_and_b32 v131, s47, v49
    v_fmac_f32 v82, v130, v98
    v_fmac_f32 v83, v131, v98
    v_fmac_f32 v90, v130, v99
    v_fmac_f32 v91, v131, v99
    v_lshlrev_b32 v128, 16, v50
    v_and_b32 v129, s47, v50
    v_fmac_f32 v84, v128, v98
    v_fmac_f32 v85, v129, v98
    v_fmac_f32 v92, v128, v99
    v_fmac_f32 v93, v129, v99
    v_lshlrev_b32 v130, 16, v51
    v_and_b32 v131, s47, v51
    v_fmac_f32 v86, v130, v98
    v_fmac_f32 v87, v131, v98
    v_fmac_f32 v94, v130, v99
    v_fmac_f32 v95, v131, v99
    s_waitcnt vmcnt(7)
    v_lshlrev_b32 v128, 16, v52
    v_and_b32 v129, s47, v52
    v_fmac_f32 v80, v128, v100
    v_fmac_f32 v81, v129, v100
    v_fmac_f32 v88, v128, v101
    v_fmac_f32 v89, v129, v101
    v_lshlrev_b32 v130, 16, v53
    v_and_b32 v131, s47, v53
    v_fmac_f32 v82, v130, v100
    v_fmac_f32 v83, v131, v100
    v_fmac_f32 v90, v130, v101
    v_fmac_f32 v91, v131, v101
    v_lshlrev_b32 v128, 16, v54
    v_and_b32 v129, s47, v54
    v_fmac_f32 v84, v128, v100
    v_fmac_f32 v85, v129, v100
    v_fmac_f32 v92, v128, v101
    v_fmac_f32 v93, v129, v101
    v_lshlrev_b32 v130, 16, v55
    v_and_b32 v131, s47, v55
    v_fmac_f32 v86, v130, v100
    v_fmac_f32 v87, v131, v100
    v_fmac_f32 v94, v130, v101
    v_fmac_f32 v95, v131, v101
    s_waitcnt vmcnt(6)
    v_lshlrev_b32 v128, 16, v56
    v_and_b32 v129, s47, v56
    v_fmac_f32 v80, v128, v102
    v_fmac_f32 v81, v129, v102
    v_fmac_f32 v88, v128, v103
    v_fmac_f32 v89, v129, v103
    v_lshlrev_b32 v130, 16, v57
    v_and_b32 v131, s47, v57
    v_fmac_f32 v82, v130, v102
    v_fmac_f32 v83, v131, v102
    v_fmac_f32 v90, v130, v103
    v_fmac_f32 v91, v131, v103
    v_lshlrev_b32 v128, 16, v58
    v_and_b32 v129, s47, v58
    v_fmac_f32 v84, v128, v102
    v_fmac_f32 v85, v129, v102
    v_fmac_f32 v92, v128, v103
    v_fmac_f32 v93, v129, v103
    v_lshlrev_b32 v130, 16, v59
    v_and_b32 v131, s47, v59
    v_fmac_f32 v86, v130, v102
    v_fmac_f32 v87, v131, v102
    v_fmac_f32 v94, v130, v103
    v_fmac_f32 v95, v131, v103
    s_waitcnt vmcnt(5)
    v_lshlrev_b32 v128, 16, v60
    v_and_b32 v129, s47, v60
    v_fmac_f32 v80, v128, v104
    v_fmac_f32 v81, v129, v104
    v_fmac_f32 v88, v128, v105
    v_fmac_f32 v89, v129, v105
    v_lshlrev_b32 v130, 16, v61
    v_and_b32 v131, s47, v61
    v_fmac_f32 v82, v130, v104
    v_fmac_f32 v83, v131, v104
    v_fmac_f32 v90, v130, v105
    v_fmac_f32 v91, v131, v105
    v_lshlrev_b32 v128, 16, v62
    v_and_b32 v129, s47, v62
    v_fmac_f32 v84, v128, v104
    v_fmac_f32 v85, v129, v104
    v_fmac_f32 v92, v128, v105
    v_fmac_f32 v93, v129, v105
    v_lshlrev_b32 v130, 16, v63
    v_and_b32 v131, s47, v63
    v_fmac_f32 v86, v130, v104
    v_fmac_f32 v87, v131, v104
    v_fmac_f32 v94, v130, v105
    v_fmac_f32 v95, v131, v105
    s_waitcnt vmcnt(4)
    v_lshlrev_b32 v128, 16, v64
    v_and_b32 v129, s47, v64
    v_fmac_f32 v80, v128, v106
    v_fmac_f32 v81, v129, v106
    v_fmac_f32 v88, v128, v107
    v_fmac_f32 v89, v129, v107
    v_lshlrev_b32 v130, 16, v65
    v_and_b32 v131, s47, v65
    v_fmac_f32 v82, v130, v106
    v_fmac_f32 v83, v131, v106
    v_fmac_f32 v90, v130, v107
    v_fmac_f32 v91, v131, v107
    v_lshlrev_b32 v128, 16, v66
    v_and_b32 v129, s47, v66
    v_fmac_f32 v84, v128, v106
    v_fmac_f32 v85, v129, v106
    v_fmac_f32 v92, v128, v107
    v_fmac_f32 v93, v129, v107
    v_lshlrev_b32 v130, 16, v67
    v_and_b32 v131, s47, v67
    v_fmac_f32 v86, v130, v106
    v_fmac_f32 v87, v131, v106
    v_fmac_f32 v94, v130, v107
    v_fmac_f32 v95, v131, v107
    s_waitcnt vmcnt(3)
    s_mov_b64 exec, 1
    v_mov_b32 v132, 160768
    v_mov_b32 v133, 1
    ds_add_u32 v132, v133 offset:4
    s_mov_b64 exec, -1
    v_lshlrev_b32 v128, 16, v68
    v_and_b32 v129, s47, v68
    v_fmac_f32 v80, v128, v108
    v_fmac_f32 v81, v129, v108
    v_fmac_f32 v88, v128, v109
    v_fmac_f32 v89, v129, v109
    v_lshlrev_b32 v130, 16, v69
    v_and_b32 v131, s47, v69
    v_fmac_f32 v82, v130, v108
    v_fmac_f32 v83, v131, v108
    v_fmac_f32 v90, v130, v109
    v_fmac_f32 v91, v131, v109
    v_lshlrev_b32 v128, 16, v70
    v_and_b32 v129, s47, v70
    v_fmac_f32 v84, v128, v108
    v_fmac_f32 v85, v129, v108
    v_fmac_f32 v92, v128, v109
    v_fmac_f32 v93, v129, v109
    v_lshlrev_b32 v130, 16, v71
    v_and_b32 v131, s47, v71
    v_fmac_f32 v86, v130, v108
    v_fmac_f32 v87, v131, v108
    v_fmac_f32 v94, v130, v109
    v_fmac_f32 v95, v131, v109
    s_waitcnt vmcnt(2)
    v_lshlrev_b32 v128, 16, v72
    v_and_b32 v129, s47, v72
    v_fmac_f32 v80, v128, v110
    v_fmac_f32 v81, v129, v110
    v_fmac_f32 v88, v128, v111
    v_fmac_f32 v89, v129, v111
    v_lshlrev_b32 v130, 16, v73
    v_and_b32 v131, s47, v73
    v_fmac_f32 v82, v130, v110
    v_fmac_f32 v83, v131, v110
    v_fmac_f32 v90, v130, v111
    v_fmac_f32 v91, v131, v111
    v_lshlrev_b32 v128, 16, v74
    v_and_b32 v129, s47, v74
    v_fmac_f32 v84, v128, v110
    v_fmac_f32 v85, v129, v110
    v_fmac_f32 v92, v128, v111
    v_fmac_f32 v93, v129, v111
    v_lshlrev_b32 v130, 16, v75
    v_and_b32 v131, s47, v75
    v_fmac_f32 v86, v130, v110
    v_fmac_f32 v87, v131, v110
    v_fmac_f32 v94, v130, v111
    v_fmac_f32 v95, v131, v111
    s_waitcnt vmcnt(1)
    v_lshlrev_b32 v128, 16, v76
    v_and_b32 v129, s47, v76
    v_fmac_f32 v80, v128, v112
    v_fmac_f32 v81, v129, v112
    v_fmac_f32 v88, v128, v113
    v_fmac_f32 v89, v129, v113
    v_lshlrev_b32 v130, 16, v77
    v_and_b32 v131, s47, v77
    v_fmac_f32 v82, v130, v112
    v_fmac_f32 v83, v131, v112
    v_fmac_f32 v90, v130, v113
    v_fmac_f32 v91, v131, v113
    v_lshlrev_b32 v128, 16, v78
    v_and_b32 v129, s47, v78
    v_fmac_f32 v84, v128, v112
    v_fmac_f32 v85, v129, v112
    v_fmac_f32 v92, v128, v113
    v_fmac_f32 v93, v129, v113
    v_lshlrev_b32 v130, 16, v79
    v_and_b32 v131, s47, v79
    v_fmac_f32 v86, v130, v112
    v_fmac_f32 v87, v131, v112
    v_fmac_f32 v94, v130, v113
    v_fmac_f32 v95, v131, v113
    v_permlane16_swap_b32 v80, v84
    v_permlane16_swap_b32 v81, v85
    v_permlane16_swap_b32 v82, v86
    v_permlane16_swap_b32 v83, v87
    v_permlane16_swap_b32 v88, v92
    v_permlane16_swap_b32 v89, v93
    v_permlane16_swap_b32 v90, v94
    v_permlane16_swap_b32 v91, v95
    v_add_f32 v80, v80, v84
    v_add_f32 v81, v81, v85
    v_add_f32 v82, v82, v86
    v_add_f32 v83, v83, v87
    v_add_f32 v88, v88, v92
    v_add_f32 v89, v89, v93
    v_add_f32 v90, v90, v94
    v_add_f32 v91, v91, v95
    v_permlane32_swap_b32 v80, v88
    v_permlane32_swap_b32 v81, v89
    v_permlane32_swap_b32 v82, v90
    v_permlane32_swap_b32 v83, v91
    v_add_f32 v80, v80, v88
    v_add_f32 v81, v81, v89
    v_add_f32 v82, v82, v90
    v_add_f32 v83, v83, v91
    v_add_f32_dpp v80, v80, v80 row_ror:8 row_mask:0xf bank_mask:0xf
    v_add_f32_dpp v81, v81, v81 row_ror:8 row_mask:0xf bank_mask:0xf
    v_add_f32_dpp v82, v82, v82 row_ror:8 row_mask:0xf bank_mask:0xf
    v_add_f32_dpp v83, v83, v83 row_ror:8 row_mask:0xf bank_mask:0xf
    ds_write_b128 v10, v[80:83]
    s_mov_b64 exec, 1
    s_lshl_b32 s60, s95, 2
    s_add_u32 s60, s60, 160784
    v_mov_b32 v132, s60
    v_mov_b32 v133, 1
    ds_add_rtn_u32 v13, v132, v133
    s_mov_b64 exec, -1
    s_waitcnt vmcnt(0)
    s_mov_b32 s48, 0
nonce_1:
    v_readfirstlane_b32 s40, v134
    s_nop 1
    s_cmp_lg_u32 s40, 0
    s_cbranch_scc1 nonced_2
    buffer_load_dword v134, v12, s[28:31], 0 offen sc0 sc1
    s_waitcnt vmcnt(0)
    s_add_u32 s48, s48, 1
    s_cmp_lt_u32 s48, 2097152
    s_cbranch_scc1 nonce_1
nonced_2:
    s_and_b32 s98, s40, 0xff
    s_bfe_u32 s41, s40, 0x80008
    s_bfe_u32 s42, s40, 0x80010
    s_lshr_b32 s43, s40, 24
    s_waitcnt lgkmcnt(0)
    v_readfirstlane_b32 s60, v13
    s_nop 1
    s_cmp_lg_u32 s60, 3
    s_cbranch_scc1 L_gemv_pub_done
    ds_read_b128 v[44:47], v14 offset:0
    ds_read_b128 v[48:51], v14 offset:512
    ds_read_b128 v[52:55], v14 offset:1024
    ds_read_b128 v[56:59], v14 offset:1536
    s_waitcnt lgkmcnt(2)
    v_add_f32 v44, v44, v48
    v_add_f32 v45, v45, v49
    v_add_f32 v46, v46, v50
    v_add_f32 v47, v47, v51
    s_waitcnt lgkmcnt(0)
    v_add_f32 v52, v52, v56
    v_add_f32 v53, v53, v57
    v_add_f32 v54, v54, v58
    v_add_f32 v55, v55, v59
    v_add_f32 v44, v44, v52
    v_add_f32 v45, v45, v53
    v_add_f32 v46, v46, v54
    v_add_f32 v47, v47, v55
    v_bfi_b32 v44, v135, s98, v44
    v_bfi_b32 v45, v135, s41, v45
    v_bfi_b32 v46, v135, s42, v46
    v_bfi_b32 v47, v135, s43, v47
    s_mov_b32 exec_lo, 0x00ff00ff
    s_mov_b32 exec_hi, 0x00ff00ff
    buffer_store_dwordx4 v[44:47], v15, s[32:35], s66 offen sc0 sc1
    s_mov_b64 exec, -1
L_gemv_pub_done:
    s_cmp_ge_u32 s39, s99
    s_cbranch_scc1 L_aux_gemv_done
L_c_main:
    v_mov_b32 v192, 0
    v_mov_b32 v193, 0
    v_mov_b32 v194, 0
    v_mov_b32 v195, 0
    v_mov_b32 v196, 0
    v_mov_b32 v197, 0
    v_mov_b32 v198, 0
    v_mov_b32 v199, 0
    v_mov_b32 v200, 0
    v_mov_b32 v201, 0
    v_mov_b32 v202, 0
    v_mov_b32 v203, 0
    v_mov_b32 v204, 0
    v_mov_b32 v205, 0
    v_mov_b32 v206, 0
    v_mov_b32 v207, 0
    v_mov_b32 v208, 0
    v_mov_b32 v209, 0
    v_mov_b32 v210, 0
    v_mov_b32 v211, 0
    v_mov_b32 v212, 0
    v_mov_b32 v213, 0
    v_mov_b32 v214, 0
    v_mov_b32 v215, 0
    v_mov_b32 v216, 0
    v_mov_b32 v217, 0
    v_mov_b32 v218, 0
    v_mov_b32 v219, 0
    v_mov_b32 v220, 0
    v_mov_b32 v221, 0
    v_mov_b32 v222, 0
    v_mov_b32 v223, 0
    v_mov_b32 v224, 0
    v_mov_b32 v225, 0
    v_mov_b32 v226, 0
    v_mov_b32 v227, 0
    v_mov_b32 v228, 0
    v_mov_b32 v229, 0
    v_mov_b32 v230, 0
    v_mov_b32 v231, 0
    v_mov_b32 v232, 0
    v_mov_b32 v233, 0
    v_mov_b32 v234, 0
    v_mov_b32 v235, 0
    v_mov_b32 v236, 0
    v_mov_b32 v237, 0
    v_mov_b32 v238, 0
    v_mov_b32 v239, 0
    v_mov_b32 v240, 0
    v_mov_b32 v241, 0
    v_mov_b32 v242, 0
    v_mov_b32 v243, 0
    v_mov_b32 v244, 0
    v_mov_b32 v245, 0
    v_mov_b32 v246, 0
    v_mov_b32 v247, 0
    v_mov_b32 v248, 0
    v_mov_b32 v249, 0
    v_mov_b32 v250, 0
    v_mov_b32 v251, 0
    v_mov_b32 v252, 0
    v_mov_b32 v253, 0
    v_mov_b32 v254, 0
    v_mov_b32 v255, 0
    s_lshr_b32 s62, s46, 2
    s_mul_i32 s62, s62, 55296
    s_lshl_b32 s60, s37, 7
    s_add_u32 s62, s62, s60
    s_add_u32 s62, s62, 1179648
    s_add_u32 s63, s62, 13824
    s_add_u32 s64, s62, 27648
    s_add_u32 s65, s62, 41472
    v_cmp_lt_u32 vcc, 7, v2
    v_mov_b32 v68, v2
    v_add_u32 v69, 64, v2
    v_subrev_u32 v71, 8, v2
    v_cndmask_b32 v69, v69, v71, vcc
    v_min_u32 v70, 15, v2
    v_add_u32 v70, 56, v70
    v_mov_b32 v71, 4608
    v_cndmask_b32 v71, 0, v71, vcc
    v_cndmask_b32 v72, 32, 0, vcc
    v_cndmask_b32 v73, 0, 1.0, vcc
    s_mul_i32 s67, s37, 2304
    s_add_u32 s67, s67, 147456
    v_lshrrev_b32 v74, 3, v68
    v_lshlrev_b32 v74, 9, v74
    v_and_b32 v75, 7, v68
    v_lshl_add_u32 v76, v75, 4, v74
    v_lshrrev_b32 v74, 1, v68
    v_lshlrev_b32 v74, 6, v74
    v_and_b32 v75, 1, v68
    v_lshl_add_u32 v74, v75, 4, v74
    v_add3_u32 v68, v74, s67, 32
    v_lshrrev_b32 v74, 3, v69
    v_lshlrev_b32 v74, 9, v74
    v_and_b32 v75, 7, v69
    v_lshl_add_u32 v77, v75, 4, v74
    v_add_u32 v77, v77, v71
    v_lshrrev_b32 v74, 1, v69
    v_lshlrev_b32 v74, 6, v74
    v_and_b32 v75, 1, v69
    v_lshl_add_u32 v74, v75, 4, v74
    v_add3_u32 v69, v74, s67, v72
    v_lshrrev_b32 v74, 3, v70
    v_lshlrev_b32 v74, 9, v74
    v_and_b32 v75, 7, v70
    v_lshl_add_u32 v78, v75, 4, v74
    v_add_u32 v78, 4608, v78
    v_lshrrev_b32 v74, 1, v70
    v_lshlrev_b32 v74, 6, v74
    v_and_b32 v75, 1, v70
    v_lshl_add_u32 v74, v75, 4, v74
    v_add3_u32 v70, v74, s67, 0
    s_lshl_b32 s60, s46, 2
    s_lshr_b32 s72, 0x42866310, s60
    s_and_b32 s72, s72, 15
    v_lshrrev_b32 v80, 2, v3
    v_and_b32 v81, 3, v3
    v_and_b32 v82, 1, v4
    v_lshl_add_u32 v82, v82, 2, v80
    s_and_b32 s61, s36, 2
    s_lshl_b32 s60, s61, 1
    v_xor_b32 v82, s60, v82
    v_lshlrev_b32 v8, 5, v82
    v_lshl_add_u32 v8, v81, 3, v8
    v_lshl_add_u32 v8, v80, 8, v8
    v_lshl_add_u32 v8, v4, 11, v8
    s_mul_i32 s60, s61, 24576
    v_add_u32 v8, s60, v8
    v_xor_b32 v9, 32, v8
    v_xor_b32 v10, 64, v8
    v_xor_b32 v11, 96, v8
    v_xor_b32 v12, 128, v8
    v_xor_b32 v13, 160, v8
    v_xor_b32 v14, 192, v8
    v_xor_b32 v15, 224, v8
    s_lshl_b32 s60, s61, 2
    v_add_u32 v80, s60, v4
    v_xor_b32 v80, v80, v3
    v_lshlrev_b32 v80, 4, v80
    v_lshl_add_u32 v80, v3, 8, v80
    s_and_b32 s60, s36, 1
    s_lshl_b32 s60, s60, 13
    s_add_u32 s60, s60, 98304
    v_add_u32 v16, s60, v80
    v_xor_b32 v17, 64, v16
    s_mul_i32 s60, s61, 2304
    s_add_u32 s60, s60, 147456
    v_lshl_add_u32 v18, v4, 6, s60
    v_lshl_add_u32 v19, s72, 8, v18
    s_xor_b32 s60, s36, 2
    s_lshl_b32 s60, s60, 13
    v_add_u32 v7, s60, v5
    s_lshl_b32 s60, s36, 13
    v_add_u32 v6, s60, v5
    s_mul_i32 s77, s45, 7282
    s_lshr_b32 s77, s77, 16
    s_mul_i32 s78, s77, 9
    s_sub_u32 s78, s45, s78
    s_lshl_b32 s78, s78, 1
    s_lshr_b32 s60, s36, 1
    s_add_u32 s78, s78, s60
    s_lshl_b32 s77, s77, 3
    s_add_u32 s77, s77, s46
    s_lshl_b32 s77, s77, 1
    s_and_b32 s60, s36, 1
    s_add_u32 s77, s77, s60
    s_mul_i32 s74, s77, 18
    s_add_u32 s74, s74, s78
    s_lshl_b32 s74, s74, 7
    s_add_u32 s74, s74, 8978432
    s_mul_i32 s75, s77, 36
    s_add_u32 s75, s75, s78
    s_lshl_b32 s75, s75, 11
    s_add_u32 s75, s75, 1310720
    s_add_u32 s76, s75, 36864
    s_lshl_b32 s60, s46, 6
    s_lshl_b32 s61, s37, 4
    s_add_u32 s68, s60, s61
    s_lshl_b32 s68, s68, 7
    s_add_u32 s68, s68, 9089024
    v_lshlrev_b32 v84, 7, v3
    s_lshl_b32 s60, s37, 2
    s_add_u32 s60, s60, 160800
    v_mov_b32 v86, s60
    v_mov_b32 v87, 1
    s_cmp_lt_u32 s96, 144
    s_cbranch_scc1 L_nopre1
    v_mov_b32 v90, 0
    buffer_load_dword v91, v90, s[28:31], 0 offen sc0 sc1
    v_mov_b32 v88, 160768
    s_mov_b32 s48, 0
ldsw_3:
    ds_read_b32 v89, v88 offset:8
    s_waitcnt lgkmcnt(0)
    v_readfirstlane_b32 s60, v89
    s_nop 1
    s_cmp_ge_u32 s60, 4
    s_cbranch_scc1 ldsd_4
    s_sleep 1
    s_add_u32 s48, s48, 1
    s_cmp_lt_u32 s48, 2097152
    s_cbranch_scc1 ldsw_3
ldsd_4:
    ds_read_b64_tr_b16 v[92:93], v8 offset:0
    ds_read_b64_tr_b16 v[94:95], v8 offset:1024
    ds_read_b64_tr_b16 v[96:97], v9 offset:0
    ds_read_b64_tr_b16 v[98:99], v9 offset:1024
    ds_read_b64_tr_b16 v[100:101], v10 offset:0
    ds_read_b64_tr_b16 v[102:103], v10 offset:1024
    ds_read_b64_tr_b16 v[104:105], v11 offset:0
    ds_read_b64_tr_b16 v[106:107], v11 offset:1024
    ds_read_b64_tr_b16 v[108:109], v12 offset:0
    ds_read_b64_tr_b16 v[110:111], v12 offset:1024
    ds_read_b64_tr_b16 v[112:113], v13 offset:0
    ds_read_b64_tr_b16 v[114:115], v13 offset:1024
    ds_read_b64_tr_b16 v[116:117], v14 offset:0
    ds_read_b64_tr_b16 v[118:119], v14 offset:1024
    ds_read_b64_tr_b16 v[120:121], v15 offset:0
    ds_read_b64_tr_b16 v[122:123], v15 offset:1024
    ds_read_b64_tr_b16 v[124:125], v8 offset:24576
    ds_read_b64_tr_b16 v[126:127], v8 offset:25600
    ds_read_b64_tr_b16 v[128:129], v9 offset:24576
    ds_read_b64_tr_b16 v[130:131], v9 offset:25600
    ds_read_b64_tr_b16 v[132:133], v10 offset:24576
    ds_read_b64_tr_b16 v[134:135], v10 offset:25600
    ds_read_b64_tr_b16 v[136:137], v11 offset:24576
    ds_read_b64_tr_b16 v[138:139], v11 offset:25600
    ds_read_b64_tr_b16 v[140:141], v12 offset:24576
    ds_read_b64_tr_b16 v[142:143], v12 offset:25600
    ds_read_b64_tr_b16 v[144:145], v13 offset:24576
    ds_read_b64_tr_b16 v[146:147], v13 offset:25600
    ds_read_b64_tr_b16 v[148:149], v14 offset:24576
    ds_read_b64_tr_b16 v[150:151], v14 offset:25600
    ds_read_b64_tr_b16 v[152:153], v15 offset:24576
    ds_read_b64_tr_b16 v[154:155], v15 offset:25600
    ds_read_b64_tr_b16 v[156:157], v8 offset:8192
    ds_read_b64_tr_b16 v[158:159], v8 offset:9216
    ds_read_b64_tr_b16 v[160:161], v9 offset:8192
    ds_read_b64_tr_b16 v[162:163], v9 offset:9216
    ds_read_b64_tr_b16 v[164:165], v10 offset:8192
    ds_read_b64_tr_b16 v[166:167], v10 offset:9216
    ds_read_b64_tr_b16 v[168:169], v11 offset:8192
    ds_read_b64_tr_b16 v[170:171], v11 offset:9216
    ds_read_b64_tr_b16 v[172:173], v12 offset:8192
    ds_read_b64_tr_b16 v[174:175], v12 offset:9216
    ds_read_b64_tr_b16 v[176:177], v13 offset:8192
    ds_read_b64_tr_b16 v[178:179], v13 offset:9216
    ds_read_b64_tr_b16 v[180:181], v14 offset:8192
    ds_read_b64_tr_b16 v[182:183], v14 offset:9216
    ds_read_b64_tr_b16 v[184:185], v15 offset:8192
    ds_read_b64_tr_b16 v[186:187], v15 offset:9216
    s_waitcnt lgkmcnt(0)
    s_mov_b64 exec, 1
    v_mov_b32 v88, 160768
    v_mov_b32 v89, 1
    ds_add_u32 v88, v89 offset:12
    s_mov_b64 exec, -1
    s_waitcnt vmcnt(0)
    s_mov_b32 s48, 0
nonce_5:
    v_readfirstlane_b32 s40, v91
    s_nop 1
    s_cmp_lg_u32 s40, 0
    s_cbranch_scc1 nonced_6
    buffer_load_dword v91, v90, s[28:31], 0 offen sc0 sc1
    s_waitcnt vmcnt(0)
    s_add_u32 s48, s48, 1
    s_cmp_lt_u32 s48, 2097152
    s_cbranch_scc1 nonce_5
nonced_6:
    s_and_b32 s98, s40, 0xff
    s_bfe_u32 s41, s40, 0x80008
    s_bfe_u32 s42, s40, 0x80010
    s_lshr_b32 s43, s40, 24
L_nopre1:
    s_mov_b32 s48, 0
poll_7:
    buffer_load_dword v85, v84, s[32:35], s68 offen sc0 sc1
    s_waitcnt vmcnt(0)
    v_cmp_ne_u32 vcc, s40, v85
    s_cbranch_vccz polld_8
    s_nop 0
    s_mov_b64 exec, vcc
    s_sleep 1
    s_add_u32 s48, s48, 1
    s_cmp_lt_u32 s48, 2097152
    s_cbranch_scc1 poll_7
polld_8:
    s_mov_b64 exec, -1
    ds_write_b32 v86, v87
    buffer_load_dwordx4 v[20:23], v76, s[32:35], s62 offen sc0 sc1
    buffer_load_dwordx4 v[24:27], v76, s[32:35], s63 offen sc0 sc1
    buffer_load_dwordx4 v[28:31], v76, s[32:35], s64 offen sc0 sc1
    buffer_load_dwordx4 v[32:35], v76, s[32:35], s65 offen sc0 sc1
    buffer_load_dwordx4 v[36:39], v77, s[32:35], s62 offen sc0 sc1
    buffer_load_dwordx4 v[40:43], v77, s[32:35], s63 offen sc0 sc1
    buffer_load_dwordx4 v[44:47], v77, s[32:35], s64 offen sc0 sc1
    buffer_load_dwordx4 v[48:51], v77, s[32:35], s65 offen sc0 sc1
    buffer_load_dwordx4 v[52:55], v78, s[32:35], s62 offen sc0 sc1
    buffer_load_dwordx4 v[56:59], v78, s[32:35], s63 offen sc0 sc1
    buffer_load_dwordx4 v[60:63], v78, s[32:35], s64 offen sc0 sc1
    buffer_load_dwordx4 v[64:67], v78, s[32:35], s65 offen sc0 sc1
    s_cmp_ge_u32 s96, 144
    s_cbranch_scc1 L_nopre2
    v_mov_b32 v88, 160768
    s_mov_b32 s48, 0
ldsw_9:
    ds_read_b32 v89, v88 offset:8
    s_waitcnt lgkmcnt(0)
    v_readfirstlane_b32 s60, v89
    s_nop 1
    s_cmp_ge_u32 s60, 4
    s_cbranch_scc1 ldsd_10
    s_sleep 1
    s_add_u32 s48, s48, 1
    s_cmp_lt_u32 s48, 2097152
    s_cbranch_scc1 ldsw_9
ldsd_10:
    ds_read_b64_tr_b16 v[92:93], v8 offset:0
    ds_read_b64_tr_b16 v[94:95], v8 offset:1024
    ds_read_b64_tr_b16 v[96:97], v9 offset:0
    ds_read_b64_tr_b16 v[98:99], v9 offset:1024
    ds_read_b64_tr_b16 v[100:101], v10 offset:0
    ds_read_b64_tr_b16 v[102:103], v10 offset:1024
    ds_read_b64_tr_b16 v[104:105], v11 offset:0
    ds_read_b64_tr_b16 v[106:107], v11 offset:1024
    ds_read_b64_tr_b16 v[108:109], v12 offset:0
    ds_read_b64_tr_b16 v[110:111], v12 offset:1024
    ds_read_b64_tr_b16 v[112:113], v13 offset:0
    ds_read_b64_tr_b16 v[114:115], v13 offset:1024
    ds_read_b64_tr_b16 v[116:117], v14 offset:0
    ds_read_b64_tr_b16 v[118:119], v14 offset:1024
    ds_read_b64_tr_b16 v[120:121], v15 offset:0
    ds_read_b64_tr_b16 v[122:123], v15 offset:1024
    ds_read_b64_tr_b16 v[124:125], v8 offset:24576
    ds_read_b64_tr_b16 v[126:127], v8 offset:25600
    ds_read_b64_tr_b16 v[128:129], v9 offset:24576
    ds_read_b64_tr_b16 v[130:131], v9 offset:25600
    ds_read_b64_tr_b16 v[132:133], v10 offset:24576
    ds_read_b64_tr_b16 v[134:135], v10 offset:25600
    ds_read_b64_tr_b16 v[136:137], v11 offset:24576
    ds_read_b64_tr_b16 v[138:139], v11 offset:25600
    ds_read_b64_tr_b16 v[140:141], v12 offset:24576
    ds_read_b64_tr_b16 v[142:143], v12 offset:25600
    ds_read_b64_tr_b16 v[144:145], v13 offset:24576
    ds_read_b64_tr_b16 v[146:147], v13 offset:25600
    ds_read_b64_tr_b16 v[148:149], v14 offset:24576
    ds_read_b64_tr_b16 v[150:151], v14 offset:25600
    ds_read_b64_tr_b16 v[152:153], v15 offset:24576
    ds_read_b64_tr_b16 v[154:155], v15 offset:25600
    ds_read_b64_tr_b16 v[156:157], v8 offset:8192
    ds_read_b64_tr_b16 v[158:159], v8 offset:9216
    ds_read_b64_tr_b16 v[160:161], v9 offset:8192
    ds_read_b64_tr_b16 v[162:163], v9 offset:9216
    ds_read_b64_tr_b16 v[164:165], v10 offset:8192
    ds_read_b64_tr_b16 v[166:167], v10 offset:9216
    ds_read_b64_tr_b16 v[168:169], v11 offset:8192
    ds_read_b64_tr_b16 v[170:171], v11 offset:9216
    ds_read_b64_tr_b16 v[172:173], v12 offset:8192
    ds_read_b64_tr_b16 v[174:175], v12 offset:9216
    ds_read_b64_tr_b16 v[176:177], v13 offset:8192
    ds_read_b64_tr_b16 v[178:179], v13 offset:9216
    ds_read_b64_tr_b16 v[180:181], v14 offset:8192
    ds_read_b64_tr_b16 v[182:183], v14 offset:9216
    ds_read_b64_tr_b16 v[184:185], v15 offset:8192
    ds_read_b64_tr_b16 v[186:187], v15 offset:9216
    s_waitcnt lgkmcnt(0)
    s_mov_b64 exec, 1
    v_mov_b32 v88, 160768
    v_mov_b32 v89, 1
    ds_add_u32 v88, v89 offset:12
    s_mov_b64 exec, -1
L_nopre2:
    s_mov_b32 s48, 0
    s_branch L_gwait
L_gather:
    buffer_load_dwordx4 v[20:23], v76, s[32:35], s62 offen sc0 sc1
    buffer_load_dwordx4 v[24:27], v76, s[32:35], s63 offen sc0 sc1
    buffer_load_dwordx4 v[28:31], v76, s[32:35], s64 offen sc0 sc1
    buffer_load_dwordx4 v[32:35], v76, s[32:35], s65 offen sc0 sc1
    buffer_load_dwordx4 v[36:39], v77, s[32:35], s62 offen sc0 sc1
    buffer_load_dwordx4 v[40:43], v77, s[32:35], s63 offen sc0 sc1
    buffer_load_dwordx4 v[44:47], v77, s[32:35], s64 offen sc0 sc1
    buffer_load_dwordx4 v[48:51], v77, s[32:35], s65 offen sc0 sc1
    buffer_load_dwordx4 v[52:55], v78, s[32:35], s62 offen sc0 sc1
    buffer_load_dwordx4 v[56:59], v78, s[32:35], s63 offen sc0 sc1
    buffer_load_dwordx4 v[60:63], v78, s[32:35], s64 offen sc0 sc1
    buffer_load_dwordx4 v[64:67], v78, s[32:35], s65 offen sc0 sc1
L_gwait:
    s_waitcnt vmcnt(0)
    v_xor_b32 v20, s98, v20
    v_xor_b32 v21, s41, v21
    v_xor_b32 v22, s42, v22
    v_xor_b32 v23, s43, v23
    v_xor_b32 v24, s98, v24
    v_xor_b32 v25, s41, v25
    v_xor_b32 v26, s42, v26
    v_xor_b32 v27, s43, v27
    v_xor_b32 v28, s98, v28
    v_xor_b32 v29, s41, v29
    v_xor_b32 v30, s42, v30
    v_xor_b32 v31, s43, v31
    v_xor_b32 v32, s98, v32
    v_xor_b32 v33, s41, v33
    v_xor_b32 v34, s42, v34
    v_xor_b32 v35, s43, v35
    v_xor_b32 v36, s98, v36
    v_xor_b32 v37, s41, v37
    v_xor_b32 v38, s42, v38
    v_xor_b32 v39, s43, v39
    v_xor_b32 v40, s98, v40
    v_xor_b32 v41, s41, v41
    v_xor_b32 v42, s42, v42
    v_xor_b32 v43, s43, v43
    v_xor_b32 v44, s98, v44
    v_xor_b32 v45, s41, v45
    v_xor_b32 v46, s42, v46
    v_xor_b32 v47, s43, v47
    v_xor_b32 v48, s98, v48
    v_xor_b32 v49, s41, v49
    v_xor_b32 v50, s42, v50
    v_xor_b32 v51, s43, v51
    v_xor_b32 v52, s98, v52
    v_xor_b32 v53, s41, v53
    v_xor_b32 v54, s42, v54
    v_xor_b32 v55, s43, v55
    v_xor_b32 v56, s98, v56
    v_xor_b32 v57, s41, v57
    v_xor_b32 v58, s42, v58
    v_xor_b32 v59, s43, v59
    v_xor_b32 v60, s98, v60
    v_xor_b32 v61, s41, v61
    v_xor_b32 v62, s42, v62
    v_xor_b32 v63, s43, v63
    v_xor_b32 v64, s98, v64
    v_xor_b32 v65, s41, v65
    v_xor_b32 v66, s42, v66
    v_xor_b32 v67, s43, v67
    v_or_b32 v79, v20, v21
    v_or3_b32 v79, v22, v23, v79
    v_or3_b32 v79, v24, v25, v79
    v_or3_b32 v79, v26, v27, v79
    v_or3_b32 v79, v28, v29, v79
    v_or3_b32 v79, v30, v31, v79
    v_or3_b32 v79, v32, v33, v79
    v_or3_b32 v79, v34, v35, v79
    v_or3_b32 v79, v36, v37, v79
    v_or3_b32 v79, v38, v39, v79
    v_or3_b32 v79, v40, v41, v79
    v_or3_b32 v79, v42, v43, v79
    v_or3_b32 v79, v44, v45, v79
    v_or3_b32 v79, v46, v47, v79
    v_or3_b32 v79, v48, v49, v79
    v_or3_b32 v79, v50, v51, v79
    v_or3_b32 v79, v52, v53, v79
    v_or3_b32 v79, v54, v55, v79
    v_or3_b32 v79, v56, v57, v79
    v_or3_b32 v79, v58, v59, v79
    v_or3_b32 v79, v60, v61, v79
    v_or3_b32 v79, v62, v63, v79
    v_or3_b32 v79, v64, v65, v79
    v_or3_b32 v79, v66, v67, v79
    v_and_b32 v79, 0xff, v79
    v_cmp_ne_u32 vcc, 0, v79
    s_cbranch_vccz L_gok
    s_add_u32 s48, s48, 1
    s_cmp_lt_u32 s48, 2097152
    s_cbranch_scc1 L_gather
L_gok:
    v_pk_add_f32 v[20:21], v[20:21], v[24:25]
    v_pk_add_f32 v[22:23], v[22:23], v[26:27]
    v_pk_add_f32 v[28:29], v[28:29], v[32:33]
    v_pk_add_f32 v[30:31], v[30:31], v[34:35]
    v_pk_add_f32 v[36:37], v[36:37], v[40:41]
    v_pk_add_f32 v[38:39], v[38:39], v[42:43]
    v_pk_add_f32 v[44:45], v[44:45], v[48:49]
    v_pk_add_f32 v[46:47], v[46:47], v[50:51]
    v_pk_add_f32 v[52:53], v[52:53], v[56:57]
    v_pk_add_f32 v[54:55], v[54:55], v[58:59]
    v_pk_add_f32 v[60:61], v[60:61], v[64:65]
    v_pk_add_f32 v[62:63], v[62:63], v[66:67]
    v_pk_add_f32 v[20:21], v[20:21], v[28:29]
    v_pk_add_f32 v[22:23], v[22:23], v[30:31]
    v_pk_add_f32 v[36:37], v[36:37], v[44:45]
    v_pk_add_f32 v[38:39], v[38:39], v[46:47]
    v_pk_add_f32 v[52:53], v[52:53], v[60:61]
    v_pk_add_f32 v[54:55], v[54:55], v[62:63]
    v_cvt_pk_bf16_f32 v24, v20, v21
    v_cvt_pk_bf16_f32 v25, v22, v23
    v_lshlrev_b32 v20, 16, v24
    v_and_b32 v21, s47, v24
    v_lshlrev_b32 v22, 16, v25
    v_and_b32 v23, s47, v25
    ds_write_b128 v68, v[20:23]
    v_cvt_pk_bf16_f32 v40, v36, v37
    v_cvt_pk_bf16_f32 v41, v38, v39
    v_lshlrev_b32 v36, 16, v40
    v_and_b32 v37, s47, v40
    v_lshlrev_b32 v38, 16, v41
    v_and_b32 v39, s47, v41
    v_add_f32 v36, v73, v36
    v_add_f32 v37, v73, v37
    v_add_f32 v38, v73, v38
    v_add_f32 v39, v73, v39
    v_cvt_pk_bf16_f32 v40, v36, v37
    v_cvt_pk_bf16_f32 v41, v38, v39
    v_lshlrev_b32 v36, 16, v40
    v_and_b32 v37, s47, v40
    v_lshlrev_b32 v38, 16, v41
    v_and_b32 v39, s47, v41
    ds_write_b128 v69, v[36:39]
    v_cvt_pk_bf16_f32 v56, v52, v53
    v_cvt_pk_bf16_f32 v57, v54, v55
    v_lshlrev_b32 v52, 16, v56
    v_and_b32 v53, s47, v56
    v_lshlrev_b32 v54, 16, v57
    v_and_b32 v55, s47, v57
    v_add_f32 v52, 1.0, v52
    v_add_f32 v53, 1.0, v53
    v_add_f32 v54, 1.0, v54
    v_add_f32 v55, 1.0, v55
    v_cvt_pk_bf16_f32 v56, v52, v53
    v_cvt_pk_bf16_f32 v57, v54, v55
    v_lshlrev_b32 v52, 16, v56
    v_and_b32 v53, s47, v56
    v_lshlrev_b32 v54, 16, v57
    v_and_b32 v55, s47, v57
    ds_write_b128 v70, v[52:55]
    s_waitcnt lgkmcnt(0)
    s_setprio 2
    s_barrier
    ds_read_b128 v[36:39], v16 offset:0
    ds_read_b128 v[40:43], v16 offset:4096
    ds_read_b128 v[44:47], v19 offset:0
    ds_read_b128 v[48:51], v19 offset:16
    ds_read_b128 v[52:55], v19 offset:32
    ds_read_b128 v[56:59], v19 offset:48
    ds_read_b128 v[60:63], v19 offset:2304
    ds_read_b128 v[64:67], v19 offset:2320
    ds_read_b128 v[68:71], v19 offset:2336
    ds_read_b128 v[72:75], v19 offset:2352
    s_add_u32 s72, s72, 1
    s_cmp_eq_u32 s72, 9
    s_cselect_b32 s72, 0, s72
    v_lshl_add_u32 v19, s72, 8, v18
    s_mov_b32 s73, 0
    s_waitcnt lgkmcnt(4)
    v_fma_mix_f32 v76, v36, v44, v52 op_sel_hi:[1,0,0]
    v_fma_mix_f32 v77, v36, v45, v53 op_sel:[1,0,0] op_sel_hi:[1,0,0]
    v_fma_mix_f32 v78, v37, v46, v54 op_sel_hi:[1,0,0]
    v_fma_mix_f32 v79, v37, v47, v55 op_sel:[1,0,0] op_sel_hi:[1,0,0]
    v_fma_mix_f32 v80, v38, v48, v56 op_sel_hi:[1,0,0]
    v_fma_mix_f32 v81, v38, v49, v57 op_sel:[1,0,0] op_sel_hi:[1,0,0]
    v_fma_mix_f32 v82, v39, v50, v58 op_sel_hi:[1,0,0]
    v_fma_mix_f32 v83, v39, v51, v59 op_sel:[1,0,0] op_sel_hi:[1,0,0]
    v_cvt_pk_bf16_f32 v20, v76, v77
    v_cvt_pk_bf16_f32 v21, v78, v79
    v_cvt_pk_bf16_f32 v22, v80, v81
    v_cvt_pk_bf16_f32 v23, v82, v83
    v_fma_mix_f32 v84, v40, v44, v52 op_sel_hi:[1,0,0]
    v_fma_mix_f32 v85, v40, v45, v53 op_sel:[1,0,0] op_sel_hi:[1,0,0]
    v_fma_mix_f32 v86, v41, v46, v54 op_sel_hi:[1,0,0]
    v_fma_mix_f32 v87, v41, v47, v55 op_sel:[1,0,0] op_sel_hi:[1,0,0]
    v_fma_mix_f32 v88, v42, v48, v56 op_sel_hi:[1,0,0]
    v_fma_mix_f32 v89, v42, v49, v57 op_sel:[1,0,0] op_sel_hi:[1,0,0]
    v_fma_mix_f32 v90, v43, v50, v58 op_sel_hi:[1,0,0]
    v_fma_mix_f32 v91, v43, v51, v59 op_sel:[1,0,0] op_sel_hi:[1,0,0]
    v_cvt_pk_bf16_f32 v24, v84, v85
    v_cvt_pk_bf16_f32 v25, v86, v87
    v_cvt_pk_bf16_f32 v26, v88, v89
    v_cvt_pk_bf16_f32 v27, v90, v91
    s_waitcnt lgkmcnt(0)
L_mm:
    v_mfma_f32_16x16x32_bf16 v[192:195], v[92:95], v[20:23], v[192:195]
    ds_read_b128 v[36:39], v17 offset:0
    ds_read_b128 v[40:43], v17 offset:4096
    v_mfma_f32_16x16x32_bf16 v[196:199], v[92:95], v[24:27], v[196:199]
    ds_read_b64_tr_b16 v[92:93], v8 offset:32768
    ds_read_b64_tr_b16 v[94:95], v8 offset:33792
    v_mfma_f32_16x16x32_bf16 v[200:203], v[96:99], v[20:23], v[200:203]
    ds_read_b128 v[44:47], v19 offset:0
    ds_read_b128 v[48:51], v19 offset:16
    v_mfma_f32_16x16x32_bf16 v[204:207], v[96:99], v[24:27], v[204:207]
    ds_read_b64_tr_b16 v[96:97], v9 offset:32768
    ds_read_b64_tr_b16 v[98:99], v9 offset:33792
    v_mfma_f32_16x16x32_bf16 v[208:211], v[100:103], v[20:23], v[208:211]
    ds_read_b128 v[52:55], v19 offset:32
    ds_read_b128 v[56:59], v19 offset:48
    s_waitcnt lgkmcnt(8)
    v_fma_mix_f32 v76, v36, v60, v68 op_sel_hi:[1,0,0]
    v_fma_mix_f32 v77, v36, v61, v69 op_sel:[1,0,0] op_sel_hi:[1,0,0]
    v_fma_mix_f32 v78, v37, v62, v70 op_sel_hi:[1,0,0]
    v_fma_mix_f32 v79, v37, v63, v71 op_sel:[1,0,0] op_sel_hi:[1,0,0]
    v_mfma_f32_16x16x32_bf16 v[212:215], v[100:103], v[24:27], v[212:215]
    ds_read_b64_tr_b16 v[100:101], v10 offset:32768
    ds_read_b64_tr_b16 v[102:103], v10 offset:33792
    v_mfma_f32_16x16x32_bf16 v[216:219], v[104:107], v[20:23], v[216:219]
    v_fma_mix_f32 v80, v38, v64, v72 op_sel_hi:[1,0,0]
    v_fma_mix_f32 v81, v38, v65, v73 op_sel:[1,0,0] op_sel_hi:[1,0,0]
    v_fma_mix_f32 v82, v39, v66, v74 op_sel_hi:[1,0,0]
    v_fma_mix_f32 v83, v39, v67, v75 op_sel:[1,0,0] op_sel_hi:[1,0,0]
    v_mfma_f32_16x16x32_bf16 v[220:223], v[104:107], v[24:27], v[220:223]
    ds_read_b64_tr_b16 v[104:105], v11 offset:32768
    ds_read_b64_tr_b16 v[106:107], v11 offset:33792
    v_mfma_f32_16x16x32_bf16 v[224:227], v[108:111], v[20:23], v[224:227]
    v_cvt_pk_bf16_f32 v28, v76, v77
    v_cvt_pk_bf16_f32 v29, v78, v79
    v_cvt_pk_bf16_f32 v30, v80, v81
    v_cvt_pk_bf16_f32 v31, v82, v83
    v_mfma_f32_16x16x32_bf16 v[228:231], v[108:111], v[24:27], v[228:231]
    ds_read_b64_tr_b16 v[108:109], v12 offset:32768
    ds_read_b64_tr_b16 v[110:111], v12 offset:33792
    v_mfma_f32_16x16x32_bf16 v[232:235], v[112:115], v[20:23], v[232:235]
    v_fma_mix_f32 v84, v40, v60, v68 op_sel_hi:[1,0,0]
    v_fma_mix_f32 v85, v40, v61, v69 op_sel:[1,0,0] op_sel_hi:[1,0,0]
    v_fma_mix_f32 v86, v41, v62, v70 op_sel_hi:[1,0,0]
    v_fma_mix_f32 v87, v41, v63, v71 op_sel:[1,0,0] op_sel_hi:[1,0,0]
    v_mfma_f32_16x16x32_bf16 v[236:239], v[112:115], v[24:27], v[236:239]
    ds_read_b64_tr_b16 v[112:113], v13 offset:32768
    ds_read_b64_tr_b16 v[114:115], v13 offset:33792
    v_mfma_f32_16x16x32_bf16 v[240:243], v[116:119], v[20:23], v[240:243]
    v_fma_mix_f32 v88, v42, v64, v72 op_sel_hi:[1,0,0]
    v_fma_mix_f32 v89, v42, v65, v73 op_sel:[1,0,0] op_sel_hi:[1,0,0]
    v_fma_mix_f32 v90, v43, v66, v74 op_sel_hi:[1,0,0]
    v_fma_mix_f32 v91, v43, v67, v75 op_sel:[1,0,0] op_sel_hi:[1,0,0]
    v_mfma_f32_16x16x32_bf16 v[244:247], v[116:119], v[24:27], v[244:247]
    ds_read_b64_tr_b16 v[116:117], v14 offset:32768
    ds_read_b64_tr_b16 v[118:119], v14 offset:33792
    v_mfma_f32_16x16x32_bf16 v[248:251], v[120:123], v[20:23], v[248:251]
    v_cvt_pk_bf16_f32 v32, v84, v85
    v_cvt_pk_bf16_f32 v33, v86, v87
    v_cvt_pk_bf16_f32 v34, v88, v89
    v_cvt_pk_bf16_f32 v35, v90, v91
    v_mfma_f32_16x16x32_bf16 v[252:255], v[120:123], v[24:27], v[252:255]
    ds_read_b64_tr_b16 v[120:121], v15 offset:32768
    ds_read_b64_tr_b16 v[122:123], v15 offset:33792
    v_mfma_f32_16x16x32_bf16 v[192:195], v[124:127], v[28:31], v[192:195]
    s_waitcnt lgkmcnt(0)
    s_barrier
    ds_read_b128 v[36:39], v16 offset:16384
    ds_read_b128 v[40:43], v16 offset:20480
    v_mfma_f32_16x16x32_bf16 v[196:199], v[124:127], v[32:35], v[196:199]
    ds_read_b64_tr_b16 v[124:125], v8 offset:16384
    ds_read_b64_tr_b16 v[126:127], v8 offset:17408
    v_mfma_f32_16x16x32_bf16 v[200:203], v[128:131], v[28:31], v[200:203]
    ds_read_b128 v[60:63], v19 offset:2304
    ds_read_b128 v[64:67], v19 offset:2320
    v_mfma_f32_16x16x32_bf16 v[204:207], v[128:131], v[32:35], v[204:207]
    ds_read_b64_tr_b16 v[128:129], v9 offset:16384
    ds_read_b64_tr_b16 v[130:131], v9 offset:17408
    v_mfma_f32_16x16x32_bf16 v[208:211], v[132:135], v[28:31], v[208:211]
    ds_read_b128 v[68:71], v19 offset:2336
    ds_read_b128 v[72:75], v19 offset:2352
    s_waitcnt lgkmcnt(8)
    v_fma_mix_f32 v76, v36, v44, v52 op_sel_hi:[1,0,0]
    v_fma_mix_f32 v77, v36, v45, v53 op_sel:[1,0,0] op_sel_hi:[1,0,0]
    v_fma_mix_f32 v78, v37, v46, v54 op_sel_hi:[1,0,0]
    v_fma_mix_f32 v79, v37, v47, v55 op_sel:[1,0,0] op_sel_hi:[1,0,0]
    v_mfma_f32_16x16x32_bf16 v[212:215], v[132:135], v[32:35], v[212:215]
    ds_read_b64_tr_b16 v[132:133], v10 offset:16384
    ds_read_b64_tr_b16 v[134:135], v10 offset:17408
    s_add_u32 s72, s72, 1
    s_cmp_eq_u32 s72, 9
    s_cselect_b32 s72, 0, s72
    v_lshl_add_u32 v19, s72, 8, v18
    v_mfma_f32_16x16x32_bf16 v[216:219], v[136:139], v[28:31], v[216:219]
    v_fma_mix_f32 v80, v38, v48, v56 op_sel_hi:[1,0,0]
    v_fma_mix_f32 v81, v38, v49, v57 op_sel:[1,0,0] op_sel_hi:[1,0,0]
    v_fma_mix_f32 v82, v39, v50, v58 op_sel_hi:[1,0,0]
    v_fma_mix_f32 v83, v39, v51, v59 op_sel:[1,0,0] op_sel_hi:[1,0,0]
    v_mfma_f32_16x16x32_bf16 v[220:223], v[136:139], v[32:35], v[220:223]
    ds_read_b64_tr_b16 v[136:137], v11 offset:16384
    ds_read_b64_tr_b16 v[138:139], v11 offset:17408
    v_mfma_f32_16x16x32_bf16 v[224:227], v[140:143], v[28:31], v[224:227]
    v_cvt_pk_bf16_f32 v20, v76, v77
    v_cvt_pk_bf16_f32 v21, v78, v79
    v_cvt_pk_bf16_f32 v22, v80, v81
    v_cvt_pk_bf16_f32 v23, v82, v83
    v_mfma_f32_16x16x32_bf16 v[228:231], v[140:143], v[32:35], v[228:231]
    ds_read_b64_tr_b16 v[140:141], v12 offset:16384
    ds_read_b64_tr_b16 v[142:143], v12 offset:17408
    v_mfma_f32_16x16x32_bf16 v[232:235], v[144:147], v[28:31], v[232:235]
    v_fma_mix_f32 v84, v40, v44, v52 op_sel_hi:[1,0,0]
    v_fma_mix_f32 v85, v40, v45, v53 op_sel:[1,0,0] op_sel_hi:[1,0,0]
    v_fma_mix_f32 v86, v41, v46, v54 op_sel_hi:[1,0,0]
    v_fma_mix_f32 v87, v41, v47, v55 op_sel:[1,0,0] op_sel_hi:[1,0,0]
    v_mfma_f32_16x16x32_bf16 v[236:239], v[144:147], v[32:35], v[236:239]
    ds_read_b64_tr_b16 v[144:145], v13 offset:16384
    ds_read_b64_tr_b16 v[146:147], v13 offset:17408
    v_mfma_f32_16x16x32_bf16 v[240:243], v[148:151], v[28:31], v[240:243]
    v_fma_mix_f32 v88, v42, v48, v56 op_sel_hi:[1,0,0]
    v_fma_mix_f32 v89, v42, v49, v57 op_sel:[1,0,0] op_sel_hi:[1,0,0]
    v_fma_mix_f32 v90, v43, v50, v58 op_sel_hi:[1,0,0]
    v_fma_mix_f32 v91, v43, v51, v59 op_sel:[1,0,0] op_sel_hi:[1,0,0]
    v_mfma_f32_16x16x32_bf16 v[244:247], v[148:151], v[32:35], v[244:247]
    ds_read_b64_tr_b16 v[148:149], v14 offset:16384
    ds_read_b64_tr_b16 v[150:151], v14 offset:17408
    v_mfma_f32_16x16x32_bf16 v[248:251], v[152:155], v[28:31], v[248:251]
    v_cvt_pk_bf16_f32 v24, v84, v85
    v_cvt_pk_bf16_f32 v25, v86, v87
    v_cvt_pk_bf16_f32 v26, v88, v89
    v_cvt_pk_bf16_f32 v27, v90, v91
    v_mfma_f32_16x16x32_bf16 v[252:255], v[152:155], v[32:35], v[252:255]
    ds_read_b64_tr_b16 v[152:153], v15 offset:16384
    ds_read_b64_tr_b16 v[154:155], v15 offset:17408
    v_mfma_f32_16x16x32_bf16 v[192:195], v[156:159], v[20:23], v[192:195]
    ds_read_b128 v[36:39], v17 offset:16384
    ds_read_b128 v[40:43], v17 offset:20480
    v_mfma_f32_16x16x32_bf16 v[196:199], v[156:159], v[24:27], v[196:199]
    ds_read_b64_tr_b16 v[156:157], v8 offset:40960
    ds_read_b64_tr_b16 v[158:159], v8 offset:41984
    v_mfma_f32_16x16x32_bf16 v[200:203], v[160:163], v[20:23], v[200:203]
    ds_read_b128 v[44:47], v19 offset:0
    ds_read_b128 v[48:51], v19 offset:16
    v_mfma_f32_16x16x32_bf16 v[204:207], v[160:163], v[24:27], v[204:207]
    ds_read_b64_tr_b16 v[160:161], v9 offset:40960
    ds_read_b64_tr_b16 v[162:163], v9 offset:41984
    v_mfma_f32_16x16x32_bf16 v[208:211], v[164:167], v[20:23], v[208:211]
    ds_read_b128 v[52:55], v19 offset:32
    ds_read_b128 v[56:59], v19 offset:48
    s_waitcnt lgkmcnt(8)
    v_fma_mix_f32 v76, v36, v60, v68 op_sel_hi:[1,0,0]
    v_fma_mix_f32 v77, v36, v61, v69 op_sel:[1,0,0] op_sel_hi:[1,0,0]
    v_fma_mix_f32 v78, v37, v62, v70 op_sel_hi:[1,0,0]
    v_fma_mix_f32 v79, v37, v63, v71 op_sel:[1,0,0] op_sel_hi:[1,0,0]
    v_mfma_f32_16x16x32_bf16 v[212:215], v[164:167], v[24:27], v[212:215]
    ds_read_b64_tr_b16 v[164:165], v10 offset:40960
    ds_read_b64_tr_b16 v[166:167], v10 offset:41984
    v_mfma_f32_16x16x32_bf16 v[216:219], v[168:171], v[20:23], v[216:219]
    v_fma_mix_f32 v80, v38, v64, v72 op_sel_hi:[1,0,0]
    v_fma_mix_f32 v81, v38, v65, v73 op_sel:[1,0,0] op_sel_hi:[1,0,0]
    v_fma_mix_f32 v82, v39, v66, v74 op_sel_hi:[1,0,0]
    v_fma_mix_f32 v83, v39, v67, v75 op_sel:[1,0,0] op_sel_hi:[1,0,0]
    v_mfma_f32_16x16x32_bf16 v[220:223], v[168:171], v[24:27], v[220:223]
    ds_read_b64_tr_b16 v[168:169], v11 offset:40960
    ds_read_b64_tr_b16 v[170:171], v11 offset:41984
    v_mfma_f32_16x16x32_bf16 v[224:227], v[172:175], v[20:23], v[224:227]
    v_cvt_pk_bf16_f32 v28, v76, v77
    v_cvt_pk_bf16_f32 v29, v78, v79
    v_cvt_pk_bf16_f32 v30, v80, v81
    v_cvt_pk_bf16_f32 v31, v82, v83
    v_mfma_f32_16x16x32_bf16 v[228:231], v[172:175], v[24:27], v[228:231]
    ds_read_b64_tr_b16 v[172:173], v12 offset:40960
    ds_read_b64_tr_b16 v[174:175], v12 offset:41984
    v_mfma_f32_16x16x32_bf16 v[232:235], v[176:179], v[20:23], v[232:235]
    v_fma_mix_f32 v84, v40, v60, v68 op_sel_hi:[1,0,0]
    v_fma_mix_f32 v85, v40, v61, v69 op_sel:[1,0,0] op_sel_hi:[1,0,0]
    v_fma_mix_f32 v86, v41, v62, v70 op_sel_hi:[1,0,0]
    v_fma_mix_f32 v87, v41, v63, v71 op_sel:[1,0,0] op_sel_hi:[1,0,0]
    v_mfma_f32_16x16x32_bf16 v[236:239], v[176:179], v[24:27], v[236:239]
    ds_read_b64_tr_b16 v[176:177], v13 offset:40960
    ds_read_b64_tr_b16 v[178:179], v13 offset:41984
    v_mfma_f32_16x16x32_bf16 v[240:243], v[180:183], v[20:23], v[240:243]
    v_fma_mix_f32 v88, v42, v64, v72 op_sel_hi:[1,0,0]
    v_fma_mix_f32 v89, v42, v65, v73 op_sel:[1,0,0] op_sel_hi:[1,0,0]
    v_fma_mix_f32 v90, v43, v66, v74 op_sel_hi:[1,0,0]
    v_fma_mix_f32 v91, v43, v67, v75 op_sel:[1,0,0] op_sel_hi:[1,0,0]
    v_mfma_f32_16x16x32_bf16 v[244:247], v[180:183], v[24:27], v[244:247]
    ds_read_b64_tr_b16 v[180:181], v14 offset:40960
    ds_read_b64_tr_b16 v[182:183], v14 offset:41984
    v_mfma_f32_16x16x32_bf16 v[248:251], v[184:187], v[20:23], v[248:251]
    v_cvt_pk_bf16_f32 v32, v84, v85
    v_cvt_pk_bf16_f32 v33, v86, v87
    v_cvt_pk_bf16_f32 v34, v88, v89
    v_cvt_pk_bf16_f32 v35, v90, v91
    v_mfma_f32_16x16x32_bf16 v[252:255], v[184:187], v[24:27], v[252:255]
    ds_read_b64_tr_b16 v[184:185], v15 offset:40960
    ds_read_b64_tr_b16 v[186:187], v15 offset:41984
    v_mfma_f32_16x16x32_bf16 v[192:195], v[92:95], v[28:31], v[192:195]
    s_waitcnt lgkmcnt(0)
    s_barrier
    ds_read_b128 v[36:39], v16 offset:32768
    ds_read_b128 v[40:43], v16 offset:36864
    v_mfma_f32_16x16x32_bf16 v[196:199], v[92:95], v[32:35], v[196:199]
    ds_read_b64_tr_b16 v[92:93], v8 offset:0
    ds_read_b64_tr_b16 v[94:95], v8 offset:1024
    v_mfma_f32_16x16x32_bf16 v[200:203], v[96:99], v[28:31], v[200:203]
    ds_read_b128 v[60:63], v19 offset:2304
    ds_read_b128 v[64:67], v19 offset:2320
    v_mfma_f32_16x16x32_bf16 v[204:207], v[96:99], v[32:35], v[204:207]
    ds_read_b64_tr_b16 v[96:97], v9 offset:0
    ds_read_b64_tr_b16 v[98:99], v9 offset:1024
    v_mfma_f32_16x16x32_bf16 v[208:211], v[100:103], v[28:31], v[208:211]
    ds_read_b128 v[68:71], v19 offset:2336
    ds_read_b128 v[72:75], v19 offset:2352
    s_waitcnt lgkmcnt(8)
    v_fma_mix_f32 v76, v36, v44, v52 op_sel_hi:[1,0,0]
    v_fma_mix_f32 v77, v36, v45, v53 op_sel:[1,0,0] op_sel_hi:[1,0,0]
    v_fma_mix_f32 v78, v37, v46, v54 op_sel_hi:[1,0,0]
    v_fma_mix_f32 v79, v37, v47, v55 op_sel:[1,0,0] op_sel_hi:[1,0,0]
    v_mfma_f32_16x16x32_bf16 v[212:215], v[100:103], v[32:35], v[212:215]
    ds_read_b64_tr_b16 v[100:101], v10 offset:0
    ds_read_b64_tr_b16 v[102:103], v10 offset:1024
    s_add_u32 s72, s72, 1
    s_cmp_eq_u32 s72, 9
    s_cselect_b32 s72, 0, s72
    v_lshl_add_u32 v19, s72, 8, v18
    v_mfma_f32_16x16x32_bf16 v[216:219], v[104:107], v[28:31], v[216:219]
    v_fma_mix_f32 v80, v38, v48, v56 op_sel_hi:[1,0,0]
    v_fma_mix_f32 v81, v38, v49, v57 op_sel:[1,0,0] op_sel_hi:[1,0,0]
    v_fma_mix_f32 v82, v39, v50, v58 op_sel_hi:[1,0,0]
    v_fma_mix_f32 v83, v39, v51, v59 op_sel:[1,0,0] op_sel_hi:[1,0,0]
    v_mfma_f32_16x16x32_bf16 v[220:223], v[104:107], v[32:35], v[220:223]
    ds_read_b64_tr_b16 v[104:105], v11 offset:0
    ds_read_b64_tr_b16 v[106:107], v11 offset:1024
    v_mfma_f32_16x16x32_bf16 v[224:227], v[108:111], v[28:31], v[224:227]
    v_cvt_pk_bf16_f32 v20, v76, v77
    v_cvt_pk_bf16_f32 v21, v78, v79
    v_cvt_pk_bf16_f32 v22, v80, v81
    v_cvt_pk_bf16_f32 v23, v82, v83
    v_mfma_f32_16x16x32_bf16 v[228:231], v[108:111], v[32:35], v[228:231]
    ds_read_b64_tr_b16 v[108:109], v12 offset:0
    ds_read_b64_tr_b16 v[110:111], v12 offset:1024
    v_mfma_f32_16x16x32_bf16 v[232:235], v[112:115], v[28:31], v[232:235]
    v_fma_mix_f32 v84, v40, v44, v52 op_sel_hi:[1,0,0]
    v_fma_mix_f32 v85, v40, v45, v53 op_sel:[1,0,0] op_sel_hi:[1,0,0]
    v_fma_mix_f32 v86, v41, v46, v54 op_sel_hi:[1,0,0]
    v_fma_mix_f32 v87, v41, v47, v55 op_sel:[1,0,0] op_sel_hi:[1,0,0]
    v_mfma_f32_16x16x32_bf16 v[236:239], v[112:115], v[32:35], v[236:239]
    ds_read_b64_tr_b16 v[112:113], v13 offset:0
    ds_read_b64_tr_b16 v[114:115], v13 offset:1024
    v_mfma_f32_16x16x32_bf16 v[240:243], v[116:119], v[28:31], v[240:243]
    v_fma_mix_f32 v88, v42, v48, v56 op_sel_hi:[1,0,0]
    v_fma_mix_f32 v89, v42, v49, v57 op_sel:[1,0,0] op_sel_hi:[1,0,0]
    v_fma_mix_f32 v90, v43, v50, v58 op_sel_hi:[1,0,0]
    v_fma_mix_f32 v91, v43, v51, v59 op_sel:[1,0,0] op_sel_hi:[1,0,0]
    v_mfma_f32_16x16x32_bf16 v[244:247], v[116:119], v[32:35], v[244:247]
    ds_read_b64_tr_b16 v[116:117], v14 offset:0
    ds_read_b64_tr_b16 v[118:119], v14 offset:1024
    v_mfma_f32_16x16x32_bf16 v[248:251], v[120:123], v[28:31], v[248:251]
    v_cvt_pk_bf16_f32 v24, v84, v85
    v_cvt_pk_bf16_f32 v25, v86, v87
    v_cvt_pk_bf16_f32 v26, v88, v89
    v_cvt_pk_bf16_f32 v27, v90, v91
    v_mfma_f32_16x16x32_bf16 v[252:255], v[120:123], v[32:35], v[252:255]
    ds_read_b64_tr_b16 v[120:121], v15 offset:0
    ds_read_b64_tr_b16 v[122:123], v15 offset:1024
    v_mfma_f32_16x16x32_bf16 v[192:195], v[124:127], v[20:23], v[192:195]
    ds_read_b128 v[36:39], v17 offset:32768
    ds_read_b128 v[40:43], v17 offset:36864
    v_mfma_f32_16x16x32_bf16 v[196:199], v[124:127], v[24:27], v[196:199]
    ds_read_b64_tr_b16 v[124:125], v8 offset:24576
    ds_read_b64_tr_b16 v[126:127], v8 offset:25600
    v_mfma_f32_16x16x32_bf16 v[200:203], v[128:131], v[20:23], v[200:203]
    ds_read_b128 v[44:47], v19 offset:0
    ds_read_b128 v[48:51], v19 offset:16
    v_mfma_f32_16x16x32_bf16 v[204:207], v[128:131], v[24:27], v[204:207]
    ds_read_b64_tr_b16 v[128:129], v9 offset:24576
    ds_read_b64_tr_b16 v[130:131], v9 offset:25600
    v_mfma_f32_16x16x32_bf16 v[208:211], v[132:135], v[20:23], v[208:211]
    ds_read_b128 v[52:55], v19 offset:32
    ds_read_b128 v[56:59], v19 offset:48
    s_waitcnt lgkmcnt(8)
    v_fma_mix_f32 v76, v36, v60, v68 op_sel_hi:[1,0,0]
    v_fma_mix_f32 v77, v36, v61, v69 op_sel:[1,0,0] op_sel_hi:[1,0,0]
    v_fma_mix_f32 v78, v37, v62, v70 op_sel_hi:[1,0,0]
    v_fma_mix_f32 v79, v37, v63, v71 op_sel:[1,0,0] op_sel_hi:[1,0,0]
    v_mfma_f32_16x16x32_bf16 v[212:215], v[132:135], v[24:27], v[212:215]
    ds_read_b64_tr_b16 v[132:133], v10 offset:24576
    ds_read_b64_tr_b16 v[134:135], v10 offset:25600
    v_mfma_f32_16x16x32_bf16 v[216:219], v[136:139], v[20:23], v[216:219]
    v_fma_mix_f32 v80, v38, v64, v72 op_sel_hi:[1,0,0]
    v_fma_mix_f32 v81, v38, v65, v73 op_sel:[1,0,0] op_sel_hi:[1,0,0]
    v_fma_mix_f32 v82, v39, v66, v74 op_sel_hi:[1,0,0]
    v_fma_mix_f32 v83, v39, v67, v75 op_sel:[1,0,0] op_sel_hi:[1,0,0]
    v_mfma_f32_16x16x32_bf16 v[220:223], v[136:139], v[24:27], v[220:223]
    ds_read_b64_tr_b16 v[136:137], v11 offset:24576
    ds_read_b64_tr_b16 v[138:139], v11 offset:25600
    v_mfma_f32_16x16x32_bf16 v[224:227], v[140:143], v[20:23], v[224:227]
    v_cvt_pk_bf16_f32 v28, v76, v77
    v_cvt_pk_bf16_f32 v29, v78, v79
    v_cvt_pk_bf16_f32 v30, v80, v81
    v_cvt_pk_bf16_f32 v31, v82, v83
    v_mfma_f32_16x16x32_bf16 v[228:231], v[140:143], v[24:27], v[228:231]
    ds_read_b64_tr_b16 v[140:141], v12 offset:24576
    ds_read_b64_tr_b16 v[142:143], v12 offset:25600
    v_mfma_f32_16x16x32_bf16 v[232:235], v[144:147], v[20:23], v[232:235]
    v_fma_mix_f32 v84, v40, v60, v68 op_sel_hi:[1,0,0]
    v_fma_mix_f32 v85, v40, v61, v69 op_sel:[1,0,0] op_sel_hi:[1,0,0]
    v_fma_mix_f32 v86, v41, v62, v70 op_sel_hi:[1,0,0]
    v_fma_mix_f32 v87, v41, v63, v71 op_sel:[1,0,0] op_sel_hi:[1,0,0]
    v_mfma_f32_16x16x32_bf16 v[236:239], v[144:147], v[24:27], v[236:239]
    ds_read_b64_tr_b16 v[144:145], v13 offset:24576
    ds_read_b64_tr_b16 v[146:147], v13 offset:25600
    v_mfma_f32_16x16x32_bf16 v[240:243], v[148:151], v[20:23], v[240:243]
    v_fma_mix_f32 v88, v42, v64, v72 op_sel_hi:[1,0,0]
    v_fma_mix_f32 v89, v42, v65, v73 op_sel:[1,0,0] op_sel_hi:[1,0,0]
    v_fma_mix_f32 v90, v43, v66, v74 op_sel_hi:[1,0,0]
    v_fma_mix_f32 v91, v43, v67, v75 op_sel:[1,0,0] op_sel_hi:[1,0,0]
    v_mfma_f32_16x16x32_bf16 v[244:247], v[148:151], v[24:27], v[244:247]
    ds_read_b64_tr_b16 v[148:149], v14 offset:24576
    ds_read_b64_tr_b16 v[150:151], v14 offset:25600
    v_mfma_f32_16x16x32_bf16 v[248:251], v[152:155], v[20:23], v[248:251]
    v_cvt_pk_bf16_f32 v32, v84, v85
    v_cvt_pk_bf16_f32 v33, v86, v87
    v_cvt_pk_bf16_f32 v34, v88, v89
    v_cvt_pk_bf16_f32 v35, v90, v91
    v_mfma_f32_16x16x32_bf16 v[252:255], v[152:155], v[24:27], v[252:255]
    ds_read_b64_tr_b16 v[152:153], v15 offset:24576
    ds_read_b64_tr_b16 v[154:155], v15 offset:25600
    v_mfma_f32_16x16x32_bf16 v[192:195], v[156:159], v[28:31], v[192:195]
    s_waitcnt lgkmcnt(0)
    s_barrier
    ds_read_b128 v[36:39], v16 offset:0
    ds_read_b128 v[40:43], v16 offset:4096
    v_mfma_f32_16x16x32_bf16 v[196:199], v[156:159], v[32:35], v[196:199]
    ds_read_b64_tr_b16 v[156:157], v8 offset:8192
    ds_read_b64_tr_b16 v[158:159], v8 offset:9216
    v_mfma_f32_16x16x32_bf16 v[200:203], v[160:163], v[28:31], v[200:203]
    ds_read_b128 v[60:63], v19 offset:2304
    ds_read_b128 v[64:67], v19 offset:2320
    v_mfma_f32_16x16x32_bf16 v[204:207], v[160:163], v[32:35], v[204:207]
    ds_read_b64_tr_b16 v[160:161], v9 offset:8192
    ds_read_b64_tr_b16 v[162:163], v9 offset:9216
    v_mfma_f32_16x16x32_bf16 v[208:211], v[164:167], v[28:31], v[208:211]
    ds_read_b128 v[68:71], v19 offset:2336
    ds_read_b128 v[72:75], v19 offset:2352
    s_waitcnt lgkmcnt(8)
    v_fma_mix_f32 v76, v36, v44, v52 op_sel_hi:[1,0,0]
    v_fma_mix_f32 v77, v36, v45, v53 op_sel:[1,0,0] op_sel_hi:[1,0,0]
    v_fma_mix_f32 v78, v37, v46, v54 op_sel_hi:[1,0,0]
    v_fma_mix_f32 v79, v37, v47, v55 op_sel:[1,0,0] op_sel_hi:[1,0,0]
    v_mfma_f32_16x16x32_bf16 v[212:215], v[164:167], v[32:35], v[212:215]
    ds_read_b64_tr_b16 v[164:165], v10 offset:8192
    ds_read_b64_tr_b16 v[166:167], v10 offset:9216
    s_add_u32 s72, s72, 1
    s_cmp_eq_u32 s72, 9
    s_cselect_b32 s72, 0, s72
    v_lshl_add_u32 v19, s72, 8, v18
    v_mfma_f32_16x16x32_bf16 v[216:219], v[168:171], v[28:31], v[216:219]
    v_fma_mix_f32 v80, v38, v48, v56 op_sel_hi:[1,0,0]
    v_fma_mix_f32 v81, v38, v49, v57 op_sel:[1,0,0] op_sel_hi:[1,0,0]
    v_fma_mix_f32 v82, v39, v50, v58 op_sel_hi:[1,0,0]
    v_fma_mix_f32 v83, v39, v51, v59 op_sel:[1,0,0] op_sel_hi:[1,0,0]
    v_mfma_f32_16x16x32_bf16 v[220:223], v[168:171], v[32:35], v[220:223]
    ds_read_b64_tr_b16 v[168:169], v11 offset:8192
    ds_read_b64_tr_b16 v[170:171], v11 offset:9216
    v_mfma_f32_16x16x32_bf16 v[224:227], v[172:175], v[28:31], v[224:227]
    v_cvt_pk_bf16_f32 v20, v76, v77
    v_cvt_pk_bf16_f32 v21, v78, v79
    v_cvt_pk_bf16_f32 v22, v80, v81
    v_cvt_pk_bf16_f32 v23, v82, v83
    v_mfma_f32_16x16x32_bf16 v[228:231], v[172:175], v[32:35], v[228:231]
    ds_read_b64_tr_b16 v[172:173], v12 offset:8192
    ds_read_b64_tr_b16 v[174:175], v12 offset:9216
    v_mfma_f32_16x16x32_bf16 v[232:235], v[176:179], v[28:31], v[232:235]
    v_fma_mix_f32 v84, v40, v44, v52 op_sel_hi:[1,0,0]
    v_fma_mix_f32 v85, v40, v45, v53 op_sel:[1,0,0] op_sel_hi:[1,0,0]
    v_fma_mix_f32 v86, v41, v46, v54 op_sel_hi:[1,0,0]
    v_fma_mix_f32 v87, v41, v47, v55 op_sel:[1,0,0] op_sel_hi:[1,0,0]
    v_mfma_f32_16x16x32_bf16 v[236:239], v[176:179], v[32:35], v[236:239]
    ds_read_b64_tr_b16 v[176:177], v13 offset:8192
    ds_read_b64_tr_b16 v[178:179], v13 offset:9216
    v_mfma_f32_16x16x32_bf16 v[240:243], v[180:183], v[28:31], v[240:243]
    v_fma_mix_f32 v88, v42, v48, v56 op_sel_hi:[1,0,0]
    v_fma_mix_f32 v89, v42, v49, v57 op_sel:[1,0,0] op_sel_hi:[1,0,0]
    v_fma_mix_f32 v90, v43, v50, v58 op_sel_hi:[1,0,0]
    v_fma_mix_f32 v91, v43, v51, v59 op_sel:[1,0,0] op_sel_hi:[1,0,0]
    v_mfma_f32_16x16x32_bf16 v[244:247], v[180:183], v[32:35], v[244:247]
    ds_read_b64_tr_b16 v[180:181], v14 offset:8192
    ds_read_b64_tr_b16 v[182:183], v14 offset:9216
    v_mfma_f32_16x16x32_bf16 v[248:251], v[184:187], v[28:31], v[248:251]
    v_cvt_pk_bf16_f32 v24, v84, v85
    v_cvt_pk_bf16_f32 v25, v86, v87
    v_cvt_pk_bf16_f32 v26, v88, v89
    v_cvt_pk_bf16_f32 v27, v90, v91
    v_mfma_f32_16x16x32_bf16 v[252:255], v[184:187], v[32:35], v[252:255]
    ds_read_b64_tr_b16 v[184:185], v15 offset:8192
    ds_read_b64_tr_b16 v[186:187], v15 offset:9216
    s_add_u32 s73, s73, 1
    s_cmp_lt_u32 s73, 2
    s_waitcnt lgkmcnt(0)
    s_cbranch_scc1 L_mm
    v_mfma_f32_16x16x32_bf16 v[192:195], v[92:95], v[20:23], v[192:195]
    ds_read_b128 v[36:39], v17 offset:0
    ds_read_b128 v[40:43], v17 offset:4096
    v_mfma_f32_16x16x32_bf16 v[196:199], v[92:95], v[24:27], v[196:199]
    ds_read_b64_tr_b16 v[92:93], v8 offset:32768
    ds_read_b64_tr_b16 v[94:95], v8 offset:33792
    v_mfma_f32_16x16x32_bf16 v[200:203], v[96:99], v[20:23], v[200:203]
    ds_read_b128 v[44:47], v19 offset:0
    ds_read_b128 v[48:51], v19 offset:16
    v_mfma_f32_16x16x32_bf16 v[204:207], v[96:99], v[24:27], v[204:207]
    ds_read_b64_tr_b16 v[96:97], v9 offset:32768
    ds_read_b64_tr_b16 v[98:99], v9 offset:33792
    v_mfma_f32_16x16x32_bf16 v[208:211], v[100:103], v[20:23], v[208:211]
    ds_read_b128 v[52:55], v19 offset:32
    ds_read_b128 v[56:59], v19 offset:48
    s_waitcnt lgkmcnt(8)
    v_fma_mix_f32 v76, v36, v60, v68 op_sel_hi:[1,0,0]
    v_fma_mix_f32 v77, v36, v61, v69 op_sel:[1,0,0] op_sel_hi:[1,0,0]
    v_fma_mix_f32 v78, v37, v62, v70 op_sel_hi:[1,0,0]
    v_fma_mix_f32 v79, v37, v63, v71 op_sel:[1,0,0] op_sel_hi:[1,0,0]
    v_mfma_f32_16x16x32_bf16 v[212:215], v[100:103], v[24:27], v[212:215]
    ds_read_b64_tr_b16 v[100:101], v10 offset:32768
    ds_read_b64_tr_b16 v[102:103], v10 offset:33792
    v_mfma_f32_16x16x32_bf16 v[216:219], v[104:107], v[20:23], v[216:219]
    v_fma_mix_f32 v80, v38, v64, v72 op_sel_hi:[1,0,0]
    v_fma_mix_f32 v81, v38, v65, v73 op_sel:[1,0,0] op_sel_hi:[1,0,0]
    v_fma_mix_f32 v82, v39, v66, v74 op_sel_hi:[1,0,0]
    v_fma_mix_f32 v83, v39, v67, v75 op_sel:[1,0,0] op_sel_hi:[1,0,0]
    v_mfma_f32_16x16x32_bf16 v[220:223], v[104:107], v[24:27], v[220:223]
    ds_read_b64_tr_b16 v[104:105], v11 offset:32768
    ds_read_b64_tr_b16 v[106:107], v11 offset:33792
    v_mfma_f32_16x16x32_bf16 v[224:227], v[108:111], v[20:23], v[224:227]
    v_cvt_pk_bf16_f32 v28, v76, v77
    v_cvt_pk_bf16_f32 v29, v78, v79
    v_cvt_pk_bf16_f32 v30, v80, v81
    v_cvt_pk_bf16_f32 v31, v82, v83
    v_mfma_f32_16x16x32_bf16 v[228:231], v[108:111], v[24:27], v[228:231]
    ds_read_b64_tr_b16 v[108:109], v12 offset:32768
    ds_read_b64_tr_b16 v[110:111], v12 offset:33792
    v_mfma_f32_16x16x32_bf16 v[232:235], v[112:115], v[20:23], v[232:235]
    v_fma_mix_f32 v84, v40, v60, v68 op_sel_hi:[1,0,0]
    v_fma_mix_f32 v85, v40, v61, v69 op_sel:[1,0,0] op_sel_hi:[1,0,0]
    v_fma_mix_f32 v86, v41, v62, v70 op_sel_hi:[1,0,0]
    v_fma_mix_f32 v87, v41, v63, v71 op_sel:[1,0,0] op_sel_hi:[1,0,0]
    v_mfma_f32_16x16x32_bf16 v[236:239], v[112:115], v[24:27], v[236:239]
    ds_read_b64_tr_b16 v[112:113], v13 offset:32768
    ds_read_b64_tr_b16 v[114:115], v13 offset:33792
    v_mfma_f32_16x16x32_bf16 v[240:243], v[116:119], v[20:23], v[240:243]
    v_fma_mix_f32 v88, v42, v64, v72 op_sel_hi:[1,0,0]
    v_fma_mix_f32 v89, v42, v65, v73 op_sel:[1,0,0] op_sel_hi:[1,0,0]
    v_fma_mix_f32 v90, v43, v66, v74 op_sel_hi:[1,0,0]
    v_fma_mix_f32 v91, v43, v67, v75 op_sel:[1,0,0] op_sel_hi:[1,0,0]
    v_mfma_f32_16x16x32_bf16 v[244:247], v[116:119], v[24:27], v[244:247]
    ds_read_b64_tr_b16 v[116:117], v14 offset:32768
    ds_read_b64_tr_b16 v[118:119], v14 offset:33792
    v_mfma_f32_16x16x32_bf16 v[248:251], v[120:123], v[20:23], v[248:251]
    v_cvt_pk_bf16_f32 v32, v84, v85
    v_cvt_pk_bf16_f32 v33, v86, v87
    v_cvt_pk_bf16_f32 v34, v88, v89
    v_cvt_pk_bf16_f32 v35, v90, v91
    v_mfma_f32_16x16x32_bf16 v[252:255], v[120:123], v[24:27], v[252:255]
    ds_read_b64_tr_b16 v[120:121], v15 offset:32768
    ds_read_b64_tr_b16 v[122:123], v15 offset:33792
    v_mfma_f32_16x16x32_bf16 v[192:195], v[124:127], v[28:31], v[192:195]
    s_waitcnt lgkmcnt(0)
    s_barrier
    ds_read_b128 v[36:39], v16 offset:16384
    ds_read_b128 v[40:43], v16 offset:20480
    v_mfma_f32_16x16x32_bf16 v[196:199], v[124:127], v[32:35], v[196:199]
    ds_read_b64_tr_b16 v[124:125], v8 offset:16384
    ds_read_b64_tr_b16 v[126:127], v8 offset:17408
    v_mfma_f32_16x16x32_bf16 v[200:203], v[128:131], v[28:31], v[200:203]
    ds_read_b128 v[60:63], v19 offset:2304
    ds_read_b128 v[64:67], v19 offset:2320
    v_mfma_f32_16x16x32_bf16 v[204:207], v[128:131], v[32:35], v[204:207]
    ds_read_b64_tr_b16 v[128:129], v9 offset:16384
    ds_read_b64_tr_b16 v[130:131], v9 offset:17408
    v_mfma_f32_16x16x32_bf16 v[208:211], v[132:135], v[28:31], v[208:211]
    ds_read_b128 v[68:71], v19 offset:2336
    ds_read_b128 v[72:75], v19 offset:2352
    s_waitcnt lgkmcnt(8)
    v_fma_mix_f32 v76, v36, v44, v52 op_sel_hi:[1,0,0]
    v_fma_mix_f32 v77, v36, v45, v53 op_sel:[1,0,0] op_sel_hi:[1,0,0]
    v_fma_mix_f32 v78, v37, v46, v54 op_sel_hi:[1,0,0]
    v_fma_mix_f32 v79, v37, v47, v55 op_sel:[1,0,0] op_sel_hi:[1,0,0]
    v_mfma_f32_16x16x32_bf16 v[212:215], v[132:135], v[32:35], v[212:215]
    ds_read_b64_tr_b16 v[132:133], v10 offset:16384
    ds_read_b64_tr_b16 v[134:135], v10 offset:17408
    s_add_u32 s72, s72, 1
    s_cmp_eq_u32 s72, 9
    s_cselect_b32 s72, 0, s72
    v_lshl_add_u32 v19, s72, 8, v18
    v_mfma_f32_16x16x32_bf16 v[216:219], v[136:139], v[28:31], v[216:219]
    v_fma_mix_f32 v80, v38, v48, v56 op_sel_hi:[1,0,0]
    v_fma_mix_f32 v81, v38, v49, v57 op_sel:[1,0,0] op_sel_hi:[1,0,0]
    v_fma_mix_f32 v82, v39, v50, v58 op_sel_hi:[1,0,0]
    v_fma_mix_f32 v83, v39, v51, v59 op_sel:[1,0,0] op_sel_hi:[1,0,0]
    v_mfma_f32_16x16x32_bf16 v[220:223], v[136:139], v[32:35], v[220:223]
    ds_read_b64_tr_b16 v[136:137], v11 offset:16384
    ds_read_b64_tr_b16 v[138:139], v11 offset:17408
    v_mfma_f32_16x16x32_bf16 v[224:227], v[140:143], v[28:31], v[224:227]
    v_cvt_pk_bf16_f32 v20, v76, v77
    v_cvt_pk_bf16_f32 v21, v78, v79
    v_cvt_pk_bf16_f32 v22, v80, v81
    v_cvt_pk_bf16_f32 v23, v82, v83
    v_mfma_f32_16x16x32_bf16 v[228:231], v[140:143], v[32:35], v[228:231]
    ds_read_b64_tr_b16 v[140:141], v12 offset:16384
    ds_read_b64_tr_b16 v[142:143], v12 offset:17408
    v_mfma_f32_16x16x32_bf16 v[232:235], v[144:147], v[28:31], v[232:235]
    v_fma_mix_f32 v84, v40, v44, v52 op_sel_hi:[1,0,0]
    v_fma_mix_f32 v85, v40, v45, v53 op_sel:[1,0,0] op_sel_hi:[1,0,0]
    v_fma_mix_f32 v86, v41, v46, v54 op_sel_hi:[1,0,0]
    v_fma_mix_f32 v87, v41, v47, v55 op_sel:[1,0,0] op_sel_hi:[1,0,0]
    v_mfma_f32_16x16x32_bf16 v[236:239], v[144:147], v[32:35], v[236:239]
    ds_read_b64_tr_b16 v[144:145], v13 offset:16384
    ds_read_b64_tr_b16 v[146:147], v13 offset:17408
    v_mfma_f32_16x16x32_bf16 v[240:243], v[148:151], v[28:31], v[240:243]
    v_fma_mix_f32 v88, v42, v48, v56 op_sel_hi:[1,0,0]
    v_fma_mix_f32 v89, v42, v49, v57 op_sel:[1,0,0] op_sel_hi:[1,0,0]
    v_fma_mix_f32 v90, v43, v50, v58 op_sel_hi:[1,0,0]
    v_fma_mix_f32 v91, v43, v51, v59 op_sel:[1,0,0] op_sel_hi:[1,0,0]
    v_mfma_f32_16x16x32_bf16 v[244:247], v[148:151], v[32:35], v[244:247]
    ds_read_b64_tr_b16 v[148:149], v14 offset:16384
    ds_read_b64_tr_b16 v[150:151], v14 offset:17408
    v_mfma_f32_16x16x32_bf16 v[248:251], v[152:155], v[28:31], v[248:251]
    v_cvt_pk_bf16_f32 v24, v84, v85
    v_cvt_pk_bf16_f32 v25, v86, v87
    v_cvt_pk_bf16_f32 v26, v88, v89
    v_cvt_pk_bf16_f32 v27, v90, v91
    v_mfma_f32_16x16x32_bf16 v[252:255], v[152:155], v[32:35], v[252:255]
    ds_read_b64_tr_b16 v[152:153], v15 offset:16384
    ds_read_b64_tr_b16 v[154:155], v15 offset:17408
    v_mfma_f32_16x16x32_bf16 v[192:195], v[156:159], v[20:23], v[192:195]
    ds_read_b128 v[36:39], v17 offset:16384
    ds_read_b128 v[40:43], v17 offset:20480
    v_mfma_f32_16x16x32_bf16 v[196:199], v[156:159], v[24:27], v[196:199]
    ds_read_b64_tr_b16 v[156:157], v8 offset:40960
    ds_read_b64_tr_b16 v[158:159], v8 offset:41984
    v_mfma_f32_16x16x32_bf16 v[200:203], v[160:163], v[20:23], v[200:203]
    ds_read_b128 v[44:47], v19 offset:0
    ds_read_b128 v[48:51], v19 offset:16
    v_mfma_f32_16x16x32_bf16 v[204:207], v[160:163], v[24:27], v[204:207]
    ds_read_b64_tr_b16 v[160:161], v9 offset:40960
    ds_read_b64_tr_b16 v[162:163], v9 offset:41984
    v_mfma_f32_16x16x32_bf16 v[208:211], v[164:167], v[20:23], v[208:211]
    ds_read_b128 v[52:55], v19 offset:32
    ds_read_b128 v[56:59], v19 offset:48
    s_waitcnt lgkmcnt(8)
    v_fma_mix_f32 v76, v36, v60, v68 op_sel_hi:[1,0,0]
    v_fma_mix_f32 v77, v36, v61, v69 op_sel:[1,0,0] op_sel_hi:[1,0,0]
    v_fma_mix_f32 v78, v37, v62, v70 op_sel_hi:[1,0,0]
    v_fma_mix_f32 v79, v37, v63, v71 op_sel:[1,0,0] op_sel_hi:[1,0,0]
    v_mfma_f32_16x16x32_bf16 v[212:215], v[164:167], v[24:27], v[212:215]
    ds_read_b64_tr_b16 v[164:165], v10 offset:40960
    ds_read_b64_tr_b16 v[166:167], v10 offset:41984
    v_mfma_f32_16x16x32_bf16 v[216:219], v[168:171], v[20:23], v[216:219]
    v_fma_mix_f32 v80, v38, v64, v72 op_sel_hi:[1,0,0]
    v_fma_mix_f32 v81, v38, v65, v73 op_sel:[1,0,0] op_sel_hi:[1,0,0]
    v_fma_mix_f32 v82, v39, v66, v74 op_sel_hi:[1,0,0]
    v_fma_mix_f32 v83, v39, v67, v75 op_sel:[1,0,0] op_sel_hi:[1,0,0]
    v_mfma_f32_16x16x32_bf16 v[220:223], v[168:171], v[24:27], v[220:223]
    ds_read_b64_tr_b16 v[168:169], v11 offset:40960
    ds_read_b64_tr_b16 v[170:171], v11 offset:41984
    v_mfma_f32_16x16x32_bf16 v[224:227], v[172:175], v[20:23], v[224:227]
    v_cvt_pk_bf16_f32 v28, v76, v77
    v_cvt_pk_bf16_f32 v29, v78, v79
    v_cvt_pk_bf16_f32 v30, v80, v81
    v_cvt_pk_bf16_f32 v31, v82, v83
    v_mfma_f32_16x16x32_bf16 v[228:231], v[172:175], v[24:27], v[228:231]
    ds_read_b64_tr_b16 v[172:173], v12 offset:40960
    ds_read_b64_tr_b16 v[174:175], v12 offset:41984
    v_mfma_f32_16x16x32_bf16 v[232:235], v[176:179], v[20:23], v[232:235]
    v_fma_mix_f32 v84, v40, v60, v68 op_sel_hi:[1,0,0]
    v_fma_mix_f32 v85, v40, v61, v69 op_sel:[1,0,0] op_sel_hi:[1,0,0]
    v_fma_mix_f32 v86, v41, v62, v70 op_sel_hi:[1,0,0]
    v_fma_mix_f32 v87, v41, v63, v71 op_sel:[1,0,0] op_sel_hi:[1,0,0]
    v_mfma_f32_16x16x32_bf16 v[236:239], v[176:179], v[24:27], v[236:239]
    ds_read_b64_tr_b16 v[176:177], v13 offset:40960
    ds_read_b64_tr_b16 v[178:179], v13 offset:41984
    v_mfma_f32_16x16x32_bf16 v[240:243], v[180:183], v[20:23], v[240:243]
    v_fma_mix_f32 v88, v42, v64, v72 op_sel_hi:[1,0,0]
    v_fma_mix_f32 v89, v42, v65, v73 op_sel:[1,0,0] op_sel_hi:[1,0,0]
    v_fma_mix_f32 v90, v43, v66, v74 op_sel_hi:[1,0,0]
    v_fma_mix_f32 v91, v43, v67, v75 op_sel:[1,0,0] op_sel_hi:[1,0,0]
    v_mfma_f32_16x16x32_bf16 v[244:247], v[180:183], v[24:27], v[244:247]
    ds_read_b64_tr_b16 v[180:181], v14 offset:40960
    ds_read_b64_tr_b16 v[182:183], v14 offset:41984
    v_mfma_f32_16x16x32_bf16 v[248:251], v[184:187], v[20:23], v[248:251]
    v_cvt_pk_bf16_f32 v32, v84, v85
    v_cvt_pk_bf16_f32 v33, v86, v87
    v_cvt_pk_bf16_f32 v34, v88, v89
    v_cvt_pk_bf16_f32 v35, v90, v91
    v_mfma_f32_16x16x32_bf16 v[252:255], v[184:187], v[24:27], v[252:255]
    ds_read_b64_tr_b16 v[184:185], v15 offset:40960
    ds_read_b64_tr_b16 v[186:187], v15 offset:41984
    v_mfma_f32_16x16x32_bf16 v[192:195], v[92:95], v[28:31], v[192:195]
    s_waitcnt lgkmcnt(0)
    s_barrier
    ds_read_b128 v[36:39], v16 offset:32768
    ds_read_b128 v[40:43], v16 offset:36864
    v_mfma_f32_16x16x32_bf16 v[196:199], v[92:95], v[32:35], v[196:199]
    v_mfma_f32_16x16x32_bf16 v[200:203], v[96:99], v[28:31], v[200:203]
    ds_read_b128 v[60:63], v19 offset:2304
    ds_read_b128 v[64:67], v19 offset:2320
    v_mfma_f32_16x16x32_bf16 v[204:207], v[96:99], v[32:35], v[204:207]
    v_mfma_f32_16x16x32_bf16 v[208:211], v[100:103], v[28:31], v[208:211]
    ds_read_b128 v[68:71], v19 offset:2336
    ds_read_b128 v[72:75], v19 offset:2352
    s_waitcnt lgkmcnt(4)
    v_fma_mix_f32 v76, v36, v44, v52 op_sel_hi:[1,0,0]
    v_fma_mix_f32 v77, v36, v45, v53 op_sel:[1,0,0] op_sel_hi:[1,0,0]
    v_fma_mix_f32 v78, v37, v46, v54 op_sel_hi:[1,0,0]
    v_fma_mix_f32 v79, v37, v47, v55 op_sel:[1,0,0] op_sel_hi:[1,0,0]
    v_mfma_f32_16x16x32_bf16 v[212:215], v[100:103], v[32:35], v[212:215]
    s_add_u32 s72, s72, 1
    s_cmp_eq_u32 s72, 9
    s_cselect_b32 s72, 0, s72
    v_lshl_add_u32 v19, s72, 8, v18
    v_mfma_f32_16x16x32_bf16 v[216:219], v[104:107], v[28:31], v[216:219]
    v_fma_mix_f32 v80, v38, v48, v56 op_sel_hi:[1,0,0]
    v_fma_mix_f32 v81, v38, v49, v57 op_sel:[1,0,0] op_sel_hi:[1,0,0]
    v_fma_mix_f32 v82, v39, v50, v58 op_sel_hi:[1,0,0]
    v_fma_mix_f32 v83, v39, v51, v59 op_sel:[1,0,0] op_sel_hi:[1,0,0]
    v_mfma_f32_16x16x32_bf16 v[220:223], v[104:107], v[32:35], v[220:223]
    v_mfma_f32_16x16x32_bf16 v[224:227], v[108:111], v[28:31], v[224:227]
    v_cvt_pk_bf16_f32 v20, v76, v77
    v_cvt_pk_bf16_f32 v21, v78, v79
    v_cvt_pk_bf16_f32 v22, v80, v81
    v_cvt_pk_bf16_f32 v23, v82, v83
    v_mfma_f32_16x16x32_bf16 v[228:231], v[108:111], v[32:35], v[228:231]
    v_mfma_f32_16x16x32_bf16 v[232:235], v[112:115], v[28:31], v[232:235]
    v_fma_mix_f32 v84, v40, v44, v52 op_sel_hi:[1,0,0]
    v_fma_mix_f32 v85, v40, v45, v53 op_sel:[1,0,0] op_sel_hi:[1,0,0]
    v_fma_mix_f32 v86, v41, v46, v54 op_sel_hi:[1,0,0]
    v_fma_mix_f32 v87, v41, v47, v55 op_sel:[1,0,0] op_sel_hi:[1,0,0]
    v_mfma_f32_16x16x32_bf16 v[236:239], v[112:115], v[32:35], v[236:239]
    v_mfma_f32_16x16x32_bf16 v[240:243], v[116:119], v[28:31], v[240:243]
    v_fma_mix_f32 v88, v42, v48, v56 op_sel_hi:[1,0,0]
    v_fma_mix_f32 v89, v42, v49, v57 op_sel:[1,0,0] op_sel_hi:[1,0,0]
    v_fma_mix_f32 v90, v43, v50, v58 op_sel_hi:[1,0,0]
    v_fma_mix_f32 v91, v43, v51, v59 op_sel:[1,0,0] op_sel_hi:[1,0,0]
    v_mfma_f32_16x16x32_bf16 v[244:247], v[116:119], v[32:35], v[244:247]
    v_mfma_f32_16x16x32_bf16 v[248:251], v[120:123], v[28:31], v[248:251]
    v_cvt_pk_bf16_f32 v24, v84, v85
    v_cvt_pk_bf16_f32 v25, v86, v87
    v_cvt_pk_bf16_f32 v26, v88, v89
    v_cvt_pk_bf16_f32 v27, v90, v91
    v_mfma_f32_16x16x32_bf16 v[252:255], v[120:123], v[32:35], v[252:255]
    v_mfma_f32_16x16x32_bf16 v[192:195], v[124:127], v[20:23], v[192:195]
    ds_read_b128 v[36:39], v17 offset:32768
    ds_read_b128 v[40:43], v17 offset:36864
    v_mfma_f32_16x16x32_bf16 v[196:199], v[124:127], v[24:27], v[196:199]
    v_mfma_f32_16x16x32_bf16 v[200:203], v[128:131], v[20:23], v[200:203]
    v_mfma_f32_16x16x32_bf16 v[204:207], v[128:131], v[24:27], v[204:207]
    v_mfma_f32_16x16x32_bf16 v[208:211], v[132:135], v[20:23], v[208:211]
    s_waitcnt lgkmcnt(0)
    v_fma_mix_f32 v76, v36, v60, v68 op_sel_hi:[1,0,0]
    v_fma_mix_f32 v77, v36, v61, v69 op_sel:[1,0,0] op_sel_hi:[1,0,0]
    v_fma_mix_f32 v78, v37, v62, v70 op_sel_hi:[1,0,0]
    v_fma_mix_f32 v79, v37, v63, v71 op_sel:[1,0,0] op_sel_hi:[1,0,0]
    v_mfma_f32_16x16x32_bf16 v[212:215], v[132:135], v[24:27], v[212:215]
    v_mfma_f32_16x16x32_bf16 v[216:219], v[136:139], v[20:23], v[216:219]
    v_fma_mix_f32 v80, v38, v64, v72 op_sel_hi:[1,0,0]
    v_fma_mix_f32 v81, v38, v65, v73 op_sel:[1,0,0] op_sel_hi:[1,0,0]
    v_fma_mix_f32 v82, v39, v66, v74 op_sel_hi:[1,0,0]
    v_fma_mix_f32 v83, v39, v67, v75 op_sel:[1,0,0] op_sel_hi:[1,0,0]
    v_mfma_f32_16x16x32_bf16 v[220:223], v[136:139], v[24:27], v[220:223]
    v_mfma_f32_16x16x32_bf16 v[224:227], v[140:143], v[20:23], v[224:227]
    v_cvt_pk_bf16_f32 v28, v76, v77
    v_cvt_pk_bf16_f32 v29, v78, v79
    v_cvt_pk_bf16_f32 v30, v80, v81
    v_cvt_pk_bf16_f32 v31, v82, v83
    v_mfma_f32_16x16x32_bf16 v[228:231], v[140:143], v[24:27], v[228:231]
    v_mfma_f32_16x16x32_bf16 v[232:235], v[144:147], v[20:23], v[232:235]
    v_fma_mix_f32 v84, v40, v60, v68 op_sel_hi:[1,0,0]
    v_fma_mix_f32 v85, v40, v61, v69 op_sel:[1,0,0] op_sel_hi:[1,0,0]
    v_fma_mix_f32 v86, v41, v62, v70 op_sel_hi:[1,0,0]
    v_fma_mix_f32 v87, v41, v63, v71 op_sel:[1,0,0] op_sel_hi:[1,0,0]
    v_mfma_f32_16x16x32_bf16 v[236:239], v[144:147], v[24:27], v[236:239]
    v_mfma_f32_16x16x32_bf16 v[240:243], v[148:151], v[20:23], v[240:243]
    v_fma_mix_f32 v88, v42, v64, v72 op_sel_hi:[1,0,0]
    v_fma_mix_f32 v89, v42, v65, v73 op_sel:[1,0,0] op_sel_hi:[1,0,0]
    v_fma_mix_f32 v90, v43, v66, v74 op_sel_hi:[1,0,0]
    v_fma_mix_f32 v91, v43, v67, v75 op_sel:[1,0,0] op_sel_hi:[1,0,0]
    v_mfma_f32_16x16x32_bf16 v[244:247], v[148:151], v[24:27], v[244:247]
    v_mfma_f32_16x16x32_bf16 v[248:251], v[152:155], v[20:23], v[248:251]
    v_cvt_pk_bf16_f32 v32, v84, v85
    v_cvt_pk_bf16_f32 v33, v86, v87
    v_cvt_pk_bf16_f32 v34, v88, v89
    v_cvt_pk_bf16_f32 v35, v90, v91
    v_mfma_f32_16x16x32_bf16 v[252:255], v[152:155], v[24:27], v[252:255]
    v_mfma_f32_16x16x32_bf16 v[224:227], v[172:175], v[28:31], v[224:227]
    v_mfma_f32_16x16x32_bf16 v[228:231], v[172:175], v[32:35], v[228:231]
    v_mfma_f32_16x16x32_bf16 v[232:235], v[176:179], v[28:31], v[232:235]
    v_mfma_f32_16x16x32_bf16 v[236:239], v[176:179], v[32:35], v[236:239]
    v_mfma_f32_16x16x32_bf16 v[240:243], v[180:183], v[28:31], v[240:243]
    v_mfma_f32_16x16x32_bf16 v[244:247], v[180:183], v[32:35], v[244:247]
    v_mfma_f32_16x16x32_bf16 v[248:251], v[184:187], v[28:31], v[248:251]
    v_mfma_f32_16x16x32_bf16 v[252:255], v[184:187], v[32:35], v[252:255]
    v_mfma_f32_16x16x32_bf16 v[192:195], v[156:159], v[28:31], v[192:195]
    ds_write_b128 v7, v[224:227] offset:0
    v_mfma_f32_16x16x32_bf16 v[196:199], v[156:159], v[32:35], v[196:199]
    ds_write_b128 v7, v[228:231] offset:1024
    v_mfma_f32_16x16x32_bf16 v[200:203], v[160:163], v[28:31], v[200:203]
    ds_write_b128 v7, v[232:235] offset:2048
    v_mfma_f32_16x16x32_bf16 v[204:207], v[160:163], v[32:35], v[204:207]
    ds_write_b128 v7, v[236:239] offset:3072
    v_mfma_f32_16x16x32_bf16 v[208:211], v[164:167], v[28:31], v[208:211]
    ds_write_b128 v7, v[240:243] offset:4096
    v_mfma_f32_16x16x32_bf16 v[212:215], v[164:167], v[32:35], v[212:215]
    ds_write_b128 v7, v[244:247] offset:5120
    v_mfma_f32_16x16x32_bf16 v[216:219], v[168:171], v[28:31], v[216:219]
    ds_write_b128 v7, v[248:251] offset:6144
    v_mfma_f32_16x16x32_bf16 v[220:223], v[168:171], v[32:35], v[220:223]
    ds_write_b128 v7, v[252:255] offset:7168
    s_setprio 0
    s_waitcnt lgkmcnt(0)
    s_barrier
    ds_read_b128 v[20:23], v6 offset:0
    ds_read_b128 v[24:27], v6 offset:1024
    ds_read_b128 v[28:31], v6 offset:2048
    ds_read_b128 v[32:35], v6 offset:3072
    ds_read_b128 v[36:39], v6 offset:4096
    ds_read_b128 v[40:43], v6 offset:5120
    ds_read_b128 v[44:47], v6 offset:6144
    ds_read_b128 v[48:51], v6 offset:7168
    s_waitcnt lgkmcnt(4)
    v_pk_add_f32 v[192:193], v[192:193], v[20:21]
    v_pk_add_f32 v[194:195], v[194:195], v[22:23]
    v_pk_add_f32 v[196:197], v[196:197], v[24:25]
    v_pk_add_f32 v[198:199], v[198:199], v[26:27]
    v_pk_add_f32 v[200:201], v[200:201], v[28:29]
    v_pk_add_f32 v[202:203], v[202:203], v[30:31]
    v_pk_add_f32 v[204:205], v[204:205], v[32:33]
    v_pk_add_f32 v[206:207], v[206:207], v[34:35]
    v_cvt_pk_bf16_f32 v60, v192, v193
    v_cvt_pk_bf16_f32 v61, v194, v195
    v_cvt_pk_bf16_f32 v62, v200, v201
    v_cvt_pk_bf16_f32 v63, v202, v203
    buffer_store_dwordx4 v[60:63], v5, s[32:35], s75 offen offset:0 sc1
    v_cvt_pk_bf16_f32 v64, v196, v197
    v_cvt_pk_bf16_f32 v65, v198, v199
    v_cvt_pk_bf16_f32 v66, v204, v205
    v_cvt_pk_bf16_f32 v67, v206, v207
    buffer_store_dwordx4 v[64:67], v5, s[32:35], s76 offen offset:0 sc1
    s_waitcnt lgkmcnt(0)
    v_pk_add_f32 v[208:209], v[208:209], v[36:37]
    v_pk_add_f32 v[210:211], v[210:211], v[38:39]
    v_pk_add_f32 v[212:213], v[212:213], v[40:41]
    v_pk_add_f32 v[214:215], v[214:215], v[42:43]
    v_pk_add_f32 v[216:217], v[216:217], v[44:45]
    v_pk_add_f32 v[218:219], v[218:219], v[46:47]
    v_pk_add_f32 v[220:221], v[220:221], v[48:49]
    v_pk_add_f32 v[222:223], v[222:223], v[50:51]
    v_cvt_pk_bf16_f32 v68, v208, v209
    v_cvt_pk_bf16_f32 v69, v210, v211
    v_cvt_pk_bf16_f32 v70, v216, v217
    v_cvt_pk_bf16_f32 v71, v218, v219
    buffer_store_dwordx4 v[68:71], v5, s[32:35], s75 offen offset:1024 sc1
    v_cvt_pk_bf16_f32 v72, v212, v213
    v_cvt_pk_bf16_f32 v73, v214, v215
    v_cvt_pk_bf16_f32 v74, v220, v221
    v_cvt_pk_bf16_f32 v75, v222, v223
    buffer_store_dwordx4 v[72:75], v5, s[32:35], s76 offen offset:1024 sc1
    s_waitcnt vmcnt(0)
    v_mov_b32 v254, 0
    v_mov_b32 v255, s40
    s_mov_b64 exec, 1
    buffer_store_dword v255, v254, s[32:35], s74 offen sc0 sc1
    s_mov_b64 exec, -1
    s_cmp_ge_u32 s39, 24
    s_cbranch_scc1 L_s_c
    s_barrier
    s_cmp_ge_u32 s36, 3
    s_cbranch_scc1 L_v_gate
    v_mul_u32_u24 v250, 2304, v3
    v_lshl_add_u32 v250, v4, 3, v250
    s_mul_i32 s89, s53, 3
    s_add_u32 s89, s89, s36
    s_mul_i32 s54, s52, 36864
    s_mul_i32 s90, s89, 96
    s_add_u32 s54, s54, s90
    buffer_load_dwordx2 v[244:245], v250, s[4:7], s54 offen offset:0
    buffer_load_dwordx2 v[246:247], v250, s[4:7], s54 offen offset:32
    buffer_load_dwordx2 v[248:249], v250, s[4:7], s54 offen offset:64
    s_lshl_b32 s63, s51, 6
    s_add_u32 s63, s63, s53
    s_mul_i32 s63, s63, 9
    s_mul_i32 s61, s36, 3
    s_add_u32 s63, s63, s61
    s_lshl_b32 s61, s63, 7
    s_add_u32 s61, s61, 9229312
    v_and_b32 v6, 7, v2
    v_bfe_u32 v7, v2, 3, 2
    v_min_u32 v7, 2, v7
    v_mul_u32_u24 v9, 72, v6
    v_add_u32 v9, v9, v7
    v_lshl_add_u32 v252, v9, 7, s61
    s_lshl_b32 s64, s52, 13
    s_add_u32 s64, s64, 8683520
    s_lshl_b32 s65, s52, 10
    s_add_u32 s65, s65, 8945664
    v_and_b32 v228, 1, v2
    v_lshlrev_b32 v228, 4, v228
    v_bfe_u32 v228, s40, v228, 16
    v_bfe_u32 v224, v228, 0, 2
    v_lshlrev_b32 v224, 14, v224
    v_lshrrev_b32 v229, 2, v228
    v_lshl_or_b32 v224, v229, 30, v224
    v_bfe_u32 v225, v228, 4, 2
    v_lshlrev_b32 v225, 14, v225
    v_lshrrev_b32 v229, 6, v228
    v_lshl_or_b32 v225, v229, 30, v225
    v_bfe_u32 v226, v228, 8, 2
    v_lshlrev_b32 v226, 14, v226
    v_lshrrev_b32 v229, 10, v228
    v_lshl_or_b32 v226, v229, 30, v226
    v_bfe_u32 v227, v228, 12, 2
    v_lshlrev_b32 v227, 14, v227
    v_lshrrev_b32 v229, 14, v228
    v_lshl_or_b32 v227, v229, 30, v227
    s_lshl_b32 s63, s63, 10
    s_add_u32 s63, s63, 7503872
    v_mov_b32 v12, 0x3f803f80
    v_mov_b32 v13, 0x3f803f80
    v_mov_b32 v14, 0x3f803f80
    v_mov_b32 v15, 0x3f803f80
    s_mul_i32 s71, s39, 3
    s_add_u32 s60, s71, 0
    s_and_b32 s60, s60, 7
    s_lshl_b32 s72, s60, 7
    s_add_u32 s72, s72, s65
    s_mul_i32 s8, s60, 73728
    s_add_u32 s8, s8, s63
    s_lshl_b32 s80, s60, 10
    s_add_u32 s80, s80, s64
    s_add_u32 s60, s71, 1
    s_and_b32 s60, s60, 7
    s_lshl_b32 s73, s60, 7
    s_add_u32 s73, s73, s65
    s_mul_i32 s9, s60, 73728
    s_add_u32 s9, s9, s63
    s_lshl_b32 s81, s60, 10
    s_add_u32 s81, s81, s64
    s_add_u32 s60, s71, 2
    s_and_b32 s60, s60, 7
    s_lshl_b32 s74, s60, 7
    s_add_u32 s74, s74, s65
    s_mul_i32 s10, s60, 73728
    s_add_u32 s10, s10, s63
    s_lshl_b32 s82, s60, 10
    s_add_u32 s82, s82, s64
    s_add_u32 s60, s71, 3
    s_and_b32 s60, s60, 7
    s_lshl_b32 s75, s60, 7
    s_add_u32 s75, s75, s65
    s_mul_i32 s11, s60, 73728
    s_add_u32 s11, s11, s63
    s_lshl_b32 s83, s60, 10
    s_add_u32 s83, s83, s64
    s_add_u32 s60, s71, 4
    s_and_b32 s60, s60, 7
    s_lshl_b32 s76, s60, 7
    s_add_u32 s76, s76, s65
    s_mul_i32 s12, s60, 73728
    s_add_u32 s12, s12, s63
    s_lshl_b32 s84, s60, 10
    s_add_u32 s84, s84, s64
    s_add_u32 s60, s71, 5
    s_and_b32 s60, s60, 7
    s_lshl_b32 s77, s60, 7
    s_add_u32 s77, s77, s65
    s_mul_i32 s13, s60, 73728
    s_add_u32 s13, s13, s63
    s_lshl_b32 s85, s60, 10
    s_add_u32 s85, s85, s64
    s_add_u32 s60, s71, 6
    s_and_b32 s60, s60, 7
    s_lshl_b32 s78, s60, 7
    s_add_u32 s78, s78, s65
    s_mul_i32 s14, s60, 73728
    s_add_u32 s14, s14, s63
    s_lshl_b32 s86, s60, 10
    s_add_u32 s86, s86, s64
    s_add_u32 s60, s71, 7
    s_and_b32 s60, s60, 7
    s_lshl_b32 s79, s60, 7
    s_add_u32 s79, s79, s65
    s_mul_i32 s15, s60, 73728
    s_add_u32 s15, s15, s63
    s_lshl_b32 s87, s60, 10
    s_add_u32 s87, s87, s64
    s_branch L_v_fin
L_v_gate:
    v_min_u32 v253, 35, v2
    v_lshlrev_b32 v253, 4, v253
    s_mul_i32 s88, s51, 55296
    s_mul_i32 s89, s53, 576
    s_add_u32 s88, s88, s89
    s_add_u32 s88, s88, 1188864
    s_add_u32 s89, s88, 13824
    s_add_u32 s90, s88, 27648
    s_add_u32 s91, s88, 41472
    s_mov_b32 s48, 0
gate_11:
    buffer_load_dwordx4 v[100:103], v253, s[32:35], s88 offen sc0 sc1
    buffer_load_dwordx4 v[104:107], v253, s[32:35], s89 offen sc0 sc1
    buffer_load_dwordx4 v[108:111], v253, s[32:35], s90 offen sc0 sc1
    buffer_load_dwordx4 v[112:115], v253, s[32:35], s91 offen sc0 sc1
    s_waitcnt vmcnt(0)
    v_xor_b32 v100, s98, v100
    v_xor_b32 v101, s41, v101
    v_xor_b32 v102, s42, v102
    v_xor_b32 v103, s43, v103
    v_xor_b32 v104, s98, v104
    v_xor_b32 v105, s41, v105
    v_xor_b32 v106, s42, v106
    v_xor_b32 v107, s43, v107
    v_xor_b32 v108, s98, v108
    v_xor_b32 v109, s41, v109
    v_xor_b32 v110, s42, v110
    v_xor_b32 v111, s43, v111
    v_xor_b32 v112, s98, v112
    v_xor_b32 v113, s41, v113
    v_xor_b32 v114, s42, v114
    v_xor_b32 v115, s43, v115
    v_or_b32 v255, v100, v101
    v_or3_b32 v255, v102, v103, v255
    v_or3_b32 v255, v104, v105, v255
    v_or3_b32 v255, v106, v107, v255
    v_or3_b32 v255, v108, v109, v255
    v_or3_b32 v255, v110, v111, v255
    v_or3_b32 v255, v112, v113, v255
    v_or3_b32 v255, v114, v115, v255
    v_and_b32 v255, 0xff, v255
    v_cmp_ne_u32 vcc, 0, v255
    s_cbranch_vccz gate_ok_12
    s_sleep 4
    s_add_u32 s48, s48, 1
    s_cmp_lt_u32 s48, 2097152
    s_cbranch_scc1 gate_11
gate_ok_12:
    v_add_f32 v100, v100, v104
    v_add_f32 v108, v108, v112
    v_add_f32 v101, v101, v105
    v_add_f32 v109, v109, v113
    v_add_f32 v102, v102, v106
    v_add_f32 v110, v110, v114
    v_add_f32 v103, v103, v107
    v_add_f32 v111, v111, v115
    v_add_f32 v100, v100, v108
    v_cvt_pk_bf16_f32 v100, v100, v100
    v_lshlrev_b32 v100, 16, v100
    v_add_f32 v101, v101, v109
    v_cvt_pk_bf16_f32 v101, v101, v101
    v_lshlrev_b32 v101, 16, v101
    v_add_f32 v102, v102, v110
    v_cvt_pk_bf16_f32 v102, v102, v102
    v_lshlrev_b32 v102, 16, v102
    v_add_f32 v103, v103, v111
    v_cvt_pk_bf16_f32 v103, v103, v103
    v_lshlrev_b32 v103, 16, v103
    v_add_u32 v253, 160832, v253
    ds_write_b128 v253, v[100:103]
    s_waitcnt lgkmcnt(0)
    s_mov_b64 exec, 1
    v_mov_b32 v253, 160768
    v_mov_b32 v254, 1
    ds_add_u32 v253, v254 offset:48
    s_mov_b64 exec, -1
    s_branch L_v_fin
L_hi:
    s_lshl_b32 s60, s46, 2
    s_lshr_b32 s80, 0x42866310, s60
    s_and_b32 s80, s80, 15
    v_lshlrev_b32 v245, 1, v4
    v_xor_b32 v245, v245, v3
    v_lshlrev_b32 v245, 4, v245
    v_mul_u32_u24 v246, 6912, v4
    s_mul_i32 s60, s37, 221184
    s_lshl_b32 s64, s45, 8
    s_add_u32 s60, s60, s64
    v_add3_u32 v240, v245, v246, s60
    v_xor_b32 v245, 128, v245
    v_add3_u32 v247, v245, v246, s60
    s_mul_i32 s75, s37, 24576
    s_and_b32 s49, s38, 4
    s_and_b32 s60, s39, 3
    s_add_u32 s49, s49, s60
    s_and_b32 s50, s38, 3
    s_mul_i32 s50, s50, 6
    s_lshr_b32 s60, s39, 2
    s_add_u32 s50, s50, s60
    s_lshr_b32 s51, s38, 2
    s_lshl_b32 s52, s51, 4
    s_and_b32 s60, s39, 15
    s_add_u32 s52, s52, s60
    s_and_b32 s53, s38, 3
    s_lshl_b32 s53, s53, 1
    s_lshr_b32 s60, s39, 4
    s_add_u32 s53, s53, s60
    s_and_b32 s60, s39, 3
    s_mul_i32 s60, s60, 2
    s_lshr_b32 s93, s39, 2
    s_mul_i32 s93, s93, 3
    s_add_u32 s60, s60, s93
    s_mul_i32 s92, s60, 7282
    s_lshr_b32 s92, s92, 16
    s_mul_i32 s93, s92, 9
    s_sub_u32 s93, s60, s93
    s_cmp_ge_u32 s39, s99
    s_cbranch_scc0 L_loader_g
L_ln_aux:
    s_waitcnt vmcnt(0)
    s_mov_b32 s48, 0
nonce_13:
    v_readfirstlane_b32 s40, v10
    s_nop 1
    s_cmp_lg_u32 s40, 0
    s_cbranch_scc1 nonced_14
    buffer_load_dword v10, v9, s[28:31], 0 offen sc0 sc1
    s_waitcnt vmcnt(0)
    s_add_u32 s48, s48, 1
    s_cmp_lt_u32 s48, 2097152
    s_cbranch_scc1 nonce_13
nonced_14:
    s_and_b32 s98, s40, 0xff
    s_bfe_u32 s41, s40, 0x80008
    s_bfe_u32 s42, s40, 0x80010
    s_lshr_b32 s43, s40, 24
    v_mov_b32 v254, 0
    v_mov_b32 v255, s40
    s_mov_b64 exec, 1
    buffer_store_dword v255, v254, s[32:35], s61 offen sc0 sc1
    s_mov_b64 exec, -1
    s_branch L_aux
L_hi_noln:
    s_mov_b32 s40, 0
    s_cmp_lt_u32 s39, s99
    s_cselect_b32 s60, s36, 0
    s_cmp_ge_u32 s60, 4
    s_cbranch_scc1 L_loader
    s_waitcnt lgkmcnt(0)
    s_barrier
L_hi_nobar:
    s_and_b32 s49, s38, 4
    s_and_b32 s60, s39, 3
    s_add_u32 s49, s49, s60
    s_and_b32 s50, s38, 3
    s_mul_i32 s50, s50, 6
    s_lshr_b32 s60, s39, 2
    s_add_u32 s50, s50, s60
    s_lshr_b32 s51, s38, 2
    s_lshl_b32 s52, s51, 4
    s_and_b32 s60, s39, 15
    s_add_u32 s52, s52, s60
    s_and_b32 s53, s38, 3
    s_lshl_b32 s53, s53, 1
    s_lshr_b32 s60, s39, 4
    s_add_u32 s53, s53, s60
    s_and_b32 s60, s39, 3
    s_mul_i32 s60, s60, 2
    s_lshr_b32 s93, s39, 2
    s_mul_i32 s93, s93, 3
    s_add_u32 s60, s60, s93
    s_mul_i32 s92, s60, 7282
    s_lshr_b32 s92, s92, 16
    s_mul_i32 s93, s92, 9
    s_sub_u32 s93, s60, s93
    s_cmp_ge_u32 s39, s99
    s_cbranch_scc1 L_aux
    s_branch L_c_main
L_loader_g:
    s_add_u32 s81, s80, 1
    s_cmp_eq_u32 s81, 9
    s_cselect_b32 s81, 0, s81
    s_add_u32 s82, s81, 1
    s_cmp_eq_u32 s82, 9
    s_cselect_b32 s82, 0, s82
    s_add_u32 s83, s82, 1
    s_cmp_eq_u32 s83, 9
    s_cselect_b32 s83, 0, s83
    s_add_u32 s84, s83, 1
    s_cmp_eq_u32 s84, 9
    s_cselect_b32 s84, 0, s84
    s_add_u32 s85, s84, 1
    s_cmp_eq_u32 s85, 9
    s_cselect_b32 s85, 0, s85
    s_add_u32 s86, s85, 1
    s_cmp_eq_u32 s86, 9
    s_cselect_b32 s86, 0, s86
    s_add_u32 s87, s86, 1
    s_cmp_eq_u32 s87, 9
    s_cselect_b32 s87, 0, s87
    s_add_u32 s88, s87, 1
    s_cmp_eq_u32 s88, 9
    s_cselect_b32 s88, 0, s88
    s_lshl_b32 s60, s46, 6
    s_lshl_b32 s64, s37, 4
    s_add_u32 s74, s60, s64
    s_mul_i32 s60, s74, 2304
    v_add_u32 v245, 0, v4
    v_xor_b32 v246, v245, v3
    v_lshlrev_b32 v246, 4, v246
    v_mul_u32_u24 v245, 2304, v245
    v_add3_u32 v241, v245, v246, s60
    v_add_u32 v245, 4, v4
    v_xor_b32 v246, v245, v3
    v_lshlrev_b32 v246, 4, v246
    v_mul_u32_u24 v245, 2304, v245
    v_add3_u32 v242, v245, v246, s60
    v_add_u32 v245, 8, v4
    v_xor_b32 v246, v245, v3
    v_lshlrev_b32 v246, 4, v246
    v_mul_u32_u24 v245, 2304, v245
    v_add3_u32 v243, v245, v246, s60
    v_add_u32 v245, 12, v4
    v_xor_b32 v246, v245, v3
    v_lshlrev_b32 v246, 4, v246
    v_mul_u32_u24 v245, 2304, v245
    v_add3_u32 v244, v245, v246, s60
    s_lshl_b32 s76, s37, 12
    s_lshl_b32 s74, s74, 7
    s_add_u32 s74, s74, 9089024
    v_lshlrev_b32 v252, 7, v3
    s_and_b32 s49, s38, 4
    s_and_b32 s60, s39, 3
    s_add_u32 s49, s49, s60
    s_and_b32 s50, s38, 3
    s_mul_i32 s50, s50, 6
    s_lshr_b32 s60, s39, 2
    s_add_u32 s50, s50, s60
    s_lshr_b32 s51, s38, 2
    s_lshl_b32 s52, s51, 4
    s_and_b32 s60, s39, 15
    s_add_u32 s52, s52, s60
    s_and_b32 s53, s38, 3
    s_lshl_b32 s53, s53, 1
    s_lshr_b32 s60, s39, 4
    s_add_u32 s53, s53, s60
    s_and_b32 s60, s39, 3
    s_mul_i32 s60, s60, 2
    s_lshr_b32 s93, s39, 2
    s_mul_i32 s93, s93, 3
    s_add_u32 s60, s60, s93
    s_mul_i32 s92, s60, 7282
    s_lshr_b32 s92, s92, 16
    s_mul_i32 s93, s92, 9
    s_sub_u32 s93, s60, s93
    s_waitcnt vmcnt(0)
    s_mov_b32 s48, 0
nonce_15:
    v_readfirstlane_b32 s40, v10
    s_nop 1
    s_cmp_lg_u32 s40, 0
    s_cbranch_scc1 nonced_16
    buffer_load_dword v10, v9, s[28:31], 0 offen sc0 sc1
    s_waitcnt vmcnt(0)
    s_add_u32 s48, s48, 1
    s_cmp_lt_u32 s48, 2097152
    s_cbranch_scc1 nonce_15
nonced_16:
    s_and_b32 s98, s40, 0xff
    s_bfe_u32 s41, s40, 0x80008
    s_bfe_u32 s42, s40, 0x80010
    s_lshr_b32 s43, s40, 24
    v_mov_b32 v254, 0
    v_mov_b32 v255, s40
    s_mov_b64 exec, 1
    buffer_store_dword v255, v254, s[32:35], s61 offen sc0 sc1
    s_mov_b64 exec, -1
    v_mov_b32 v12, 160768
    s_mov_b32 s48, 0
ldsw_17:
    ds_read_b32 v13, v12 offset:4
    s_waitcnt lgkmcnt(0)
    v_readfirstlane_b32 s60, v13
    s_nop 1
    s_cmp_ge_u32 s60, 4
    s_cbranch_scc1 ldsd_18
    s_sleep 1
    s_add_u32 s48, s48, 1
    s_cmp_lt_u32 s48, 2097152
    s_cbranch_scc1 ldsw_17
ldsd_18:
    s_add_u32 m0, s75, 0
    s_mul_i32 s77, s80, 884736
    buffer_load_dwordx4 v240, s[12:15], s77 offen  lds
    s_add_u32 m0, s75, 1024
    s_add_u32 s77, s77, 27648
    buffer_load_dwordx4 v240, s[12:15], s77 offen  lds
    s_add_u32 m0, s75, 2048
    s_add_u32 s77, s77, 27648
    buffer_load_dwordx4 v247, s[12:15], s77 offen  lds
    s_add_u32 m0, s75, 3072
    s_add_u32 s77, s77, 27648
    buffer_load_dwordx4 v247, s[12:15], s77 offen  lds
    s_add_u32 m0, s75, 4096
    s_add_u32 s77, s77, 27648
    buffer_load_dwordx4 v240, s[12:15], s77 offen  lds
    s_add_u32 m0, s75, 5120
    s_add_u32 s77, s77, 27648
    buffer_load_dwordx4 v240, s[12:15], s77 offen  lds
    s_add_u32 m0, s75, 6144
    s_add_u32 s77, s77, 27648
    buffer_load_dwordx4 v247, s[12:15], s77 offen  lds
    s_add_u32 m0, s75, 7168
    s_add_u32 s77, s77, 27648
    buffer_load_dwordx4 v247, s[12:15], s77 offen  lds
    s_add_u32 m0, s75, 8192
    s_mul_i32 s77, s81, 884736
    buffer_load_dwordx4 v240, s[12:15], s77 offen  lds
    s_add_u32 m0, s75, 9216
    s_add_u32 s77, s77, 27648
    buffer_load_dwordx4 v240, s[12:15], s77 offen  lds
    s_add_u32 m0, s75, 10240
    s_add_u32 s77, s77, 27648
    buffer_load_dwordx4 v247, s[12:15], s77 offen  lds
    s_add_u32 m0, s75, 11264
    s_add_u32 s77, s77, 27648
    buffer_load_dwordx4 v247, s[12:15], s77 offen  lds
    s_add_u32 m0, s75, 12288
    s_add_u32 s77, s77, 27648
    buffer_load_dwordx4 v240, s[12:15], s77 offen  lds
    s_add_u32 m0, s75, 13312
    s_add_u32 s77, s77, 27648
    buffer_load_dwordx4 v240, s[12:15], s77 offen  lds
    s_add_u32 m0, s75, 14336
    s_add_u32 s77, s77, 27648
    buffer_load_dwordx4 v247, s[12:15], s77 offen  lds
    s_add_u32 m0, s75, 15360
    s_add_u32 s77, s77, 27648
    buffer_load_dwordx4 v247, s[12:15], s77 offen  lds
    s_waitcnt vmcnt(0)
    s_mov_b64 exec, 1
    v_mov_b32 v12, 160768
    v_mov_b32 v13, 1
    ds_add_u32 v12, v13 offset:8
    s_mov_b64 exec, -1
    v_mov_b32 v12, 160768
    v_lshl_add_u32 v12, s37, 2, v12
    s_mov_b32 s48, 0
ldsw_19:
    ds_read_b32 v13, v12 offset:32
    s_waitcnt lgkmcnt(0)
    v_readfirstlane_b32 s60, v13
    s_nop 1
    s_cmp_ge_u32 s60, 1
    s_cbranch_scc1 ldsd_20
    s_sleep 1
    s_add_u32 s48, s48, 1
    s_cmp_lt_u32 s48, 2097152
    s_cbranch_scc1 ldsw_19
ldsd_20:
    s_add_u32 m0, s76, 98304
    s_lshl_b32 s77, s80, 8
    buffer_load_dwordx4 v241, s[32:35], s77 offen sc1 lds
    s_add_u32 m0, s76, 99328
    s_nop 0
    buffer_load_dwordx4 v242, s[32:35], s77 offen sc1 lds
    s_add_u32 m0, s76, 100352
    s_nop 0
    buffer_load_dwordx4 v243, s[32:35], s77 offen sc1 lds
    s_add_u32 m0, s76, 101376
    s_nop 0
    buffer_load_dwordx4 v244, s[32:35], s77 offen sc1 lds
    s_add_u32 m0, s76, 114688
    s_lshl_b32 s77, s81, 8
    buffer_load_dwordx4 v241, s[32:35], s77 offen sc1 lds
    s_add_u32 m0, s76, 115712
    s_nop 0
    buffer_load_dwordx4 v242, s[32:35], s77 offen sc1 lds
    s_add_u32 m0, s76, 116736
    s_nop 0
    buffer_load_dwordx4 v243, s[32:35], s77 offen sc1 lds
    s_add_u32 m0, s76, 117760
    s_nop 0
    buffer_load_dwordx4 v244, s[32:35], s77 offen sc1 lds
    s_add_u32 m0, s75, 16384
    s_mul_i32 s77, s82, 884736
    buffer_load_dwordx4 v240, s[12:15], s77 offen  lds
    s_add_u32 m0, s75, 17408
    s_add_u32 s77, s77, 27648
    buffer_load_dwordx4 v240, s[12:15], s77 offen  lds
    s_add_u32 m0, s75, 18432
    s_add_u32 s77, s77, 27648
    buffer_load_dwordx4 v247, s[12:15], s77 offen  lds
    s_add_u32 m0, s75, 19456
    s_add_u32 s77, s77, 27648
    buffer_load_dwordx4 v247, s[12:15], s77 offen  lds
    s_add_u32 m0, s75, 20480
    s_add_u32 s77, s77, 27648
    buffer_load_dwordx4 v240, s[12:15], s77 offen  lds
    s_add_u32 m0, s75, 21504
    s_add_u32 s77, s77, 27648
    buffer_load_dwordx4 v240, s[12:15], s77 offen  lds
    s_add_u32 m0, s75, 22528
    s_add_u32 s77, s77, 27648
    buffer_load_dwordx4 v247, s[12:15], s77 offen  lds
    s_add_u32 m0, s75, 23552
    s_add_u32 s77, s77, 27648
    buffer_load_dwordx4 v247, s[12:15], s77 offen  lds
    s_waitcnt vmcnt(12)
    s_barrier
    s_add_u32 m0, s76, 131072
    s_lshl_b32 s77, s82, 8
    buffer_load_dwordx4 v241, s[32:35], s77 offen sc1 lds
    s_add_u32 m0, s76, 132096
    s_nop 0
    buffer_load_dwordx4 v242, s[32:35], s77 offen sc1 lds
    s_add_u32 m0, s76, 133120
    s_nop 0
    buffer_load_dwordx4 v243, s[32:35], s77 offen sc1 lds
    s_add_u32 m0, s76, 134144
    s_nop 0
    buffer_load_dwordx4 v244, s[32:35], s77 offen sc1 lds
    v_mov_b32 v12, 160768
    s_mov_b32 s48, 0
ldsw_21:
    ds_read_b32 v13, v12 offset:12
    s_waitcnt lgkmcnt(0)
    v_readfirstlane_b32 s60, v13
    s_nop 1
    s_cmp_ge_u32 s60, 4
    s_cbranch_scc1 ldsd_22
    s_sleep 1
    s_add_u32 s48, s48, 1
    s_cmp_lt_u32 s48, 2097152
    s_cbranch_scc1 ldsw_21
ldsd_22:
    s_add_u32 m0, s75, 0
    s_mul_i32 s77, s83, 884736
    buffer_load_dwordx4 v240, s[12:15], s77 offen  lds
    s_add_u32 m0, s75, 1024
    s_add_u32 s77, s77, 27648
    buffer_load_dwordx4 v240, s[12:15], s77 offen  lds
    s_add_u32 m0, s75, 2048
    s_add_u32 s77, s77, 27648
    buffer_load_dwordx4 v247, s[12:15], s77 offen  lds
    s_add_u32 m0, s75, 3072
    s_add_u32 s77, s77, 27648
    buffer_load_dwordx4 v247, s[12:15], s77 offen  lds
    s_add_u32 m0, s75, 4096
    s_add_u32 s77, s77, 27648
    buffer_load_dwordx4 v240, s[12:15], s77 offen  lds
    s_add_u32 m0, s75, 5120
    s_add_u32 s77, s77, 27648
    buffer_load_dwordx4 v240, s[12:15], s77 offen  lds
    s_add_u32 m0, s75, 6144
    s_add_u32 s77, s77, 27648
    buffer_load_dwordx4 v247, s[12:15], s77 offen  lds
    s_add_u32 m0, s75, 7168
    s_add_u32 s77, s77, 27648
    buffer_load_dwordx4 v247, s[12:15], s77 offen  lds
    s_waitcnt vmcnt(12)
    s_branch L_ljoin
L_loader:
    s_lshl_b32 s60, s46, 2
    s_lshr_b32 s80, 0x42866310, s60
    s_and_b32 s80, s80, 15
    v_lshlrev_b32 v245, 1, v4
    v_xor_b32 v245, v245, v3
    v_lshlrev_b32 v245, 4, v245
    v_mul_u32_u24 v246, 6912, v4
    s_mul_i32 s60, s37, 221184
    s_lshl_b32 s64, s45, 8
    s_add_u32 s60, s60, s64
    v_add3_u32 v240, v245, v246, s60
    v_xor_b32 v245, 128, v245
    v_add3_u32 v247, v245, v246, s60
    s_mul_i32 s75, s37, 24576
    s_waitcnt lgkmcnt(0)
    s_add_u32 m0, s75, 0
    s_mul_i32 s77, s80, 884736
    buffer_load_dwordx4 v240, s[12:15], s77 offen  lds
    s_add_u32 m0, s75, 1024
    s_add_u32 s77, s77, 27648
    buffer_load_dwordx4 v240, s[12:15], s77 offen  lds
    s_add_u32 m0, s75, 2048
    s_add_u32 s77, s77, 27648
    buffer_load_dwordx4 v247, s[12:15], s77 offen  lds
    s_add_u32 m0, s75, 3072
    s_add_u32 s77, s77, 27648
    buffer_load_dwordx4 v247, s[12:15], s77 offen  lds
    s_add_u32 m0, s75, 4096
    s_add_u32 s77, s77, 27648
    buffer_load_dwordx4 v240, s[12:15], s77 offen  lds
    s_add_u32 m0, s75, 5120
    s_add_u32 s77, s77, 27648
    buffer_load_dwordx4 v240, s[12:15], s77 offen  lds
    s_add_u32 m0, s75, 6144
    s_add_u32 s77, s77, 27648
    buffer_load_dwordx4 v247, s[12:15], s77 offen  lds
    s_add_u32 m0, s75, 7168
    s_add_u32 s77, s77, 27648
    buffer_load_dwordx4 v247, s[12:15], s77 offen  lds
    s_barrier
    s_add_u32 s81, s80, 1
    s_cmp_eq_u32 s81, 9
    s_cselect_b32 s81, 0, s81
    s_add_u32 s82, s81, 1
    s_cmp_eq_u32 s82, 9
    s_cselect_b32 s82, 0, s82
    s_add_u32 s83, s82, 1
    s_cmp_eq_u32 s83, 9
    s_cselect_b32 s83, 0, s83
    s_add_u32 s84, s83, 1
    s_cmp_eq_u32 s84, 9
    s_cselect_b32 s84, 0, s84
    s_add_u32 s85, s84, 1
    s_cmp_eq_u32 s85, 9
    s_cselect_b32 s85, 0, s85
    s_add_u32 s86, s85, 1
    s_cmp_eq_u32 s86, 9
    s_cselect_b32 s86, 0, s86
    s_add_u32 s87, s86, 1
    s_cmp_eq_u32 s87, 9
    s_cselect_b32 s87, 0, s87
    s_add_u32 s88, s87, 1
    s_cmp_eq_u32 s88, 9
    s_cselect_b32 s88, 0, s88
    s_lshl_b32 s60, s46, 6
    s_lshl_b32 s64, s37, 4
    s_add_u32 s74, s60, s64
    s_mul_i32 s60, s74, 2304
    v_add_u32 v245, 0, v4
    v_xor_b32 v246, v245, v3
    v_lshlrev_b32 v246, 4, v246
    v_mul_u32_u24 v245, 2304, v245
    v_add3_u32 v241, v245, v246, s60
    v_add_u32 v245, 4, v4
    v_xor_b32 v246, v245, v3
    v_lshlrev_b32 v246, 4, v246
    v_mul_u32_u24 v245, 2304, v245
    v_add3_u32 v242, v245, v246, s60
    v_add_u32 v245, 8, v4
    v_xor_b32 v246, v245, v3
    v_lshlrev_b32 v246, 4, v246
    v_mul_u32_u24 v245, 2304, v245
    v_add3_u32 v243, v245, v246, s60
    v_add_u32 v245, 12, v4
    v_xor_b32 v246, v245, v3
    v_lshlrev_b32 v246, 4, v246
    v_mul_u32_u24 v245, 2304, v245
    v_add3_u32 v244, v245, v246, s60
    s_lshl_b32 s76, s37, 12
    s_lshl_b32 s74, s74, 7
    s_add_u32 s74, s74, 9089024
    v_lshlrev_b32 v252, 7, v3
    s_and_b32 s49, s38, 4
    s_and_b32 s60, s39, 3
    s_add_u32 s49, s49, s60
    s_and_b32 s50, s38, 3
    s_mul_i32 s50, s50, 6
    s_lshr_b32 s60, s39, 2
    s_add_u32 s50, s50, s60
    s_lshr_b32 s51, s38, 2
    s_lshl_b32 s52, s51, 4
    s_and_b32 s60, s39, 15
    s_add_u32 s52, s52, s60
    s_and_b32 s53, s38, 3
    s_lshl_b32 s53, s53, 1
    s_lshr_b32 s60, s39, 4
    s_add_u32 s53, s53, s60
    s_and_b32 s60, s39, 3
    s_mul_i32 s60, s60, 2
    s_lshr_b32 s93, s39, 2
    s_mul_i32 s93, s93, 3
    s_add_u32 s60, s60, s93
    s_mul_i32 s92, s60, 7282
    s_lshr_b32 s92, s92, 16
    s_mul_i32 s93, s92, 9
    s_sub_u32 s93, s60, s93
    s_add_u32 m0, s75, 8192
    s_mul_i32 s77, s81, 884736
    buffer_load_dwordx4 v240, s[12:15], s77 offen  lds
    s_add_u32 m0, s75, 9216
    s_add_u32 s77, s77, 27648
    buffer_load_dwordx4 v240, s[12:15], s77 offen  lds
    s_add_u32 m0, s75, 10240
    s_add_u32 s77, s77, 27648
    buffer_load_dwordx4 v247, s[12:15], s77 offen  lds
    s_add_u32 m0, s75, 11264
    s_add_u32 s77, s77, 27648
    buffer_load_dwordx4 v247, s[12:15], s77 offen  lds
    s_add_u32 m0, s75, 12288
    s_add_u32 s77, s77, 27648
    buffer_load_dwordx4 v240, s[12:15], s77 offen  lds
    s_add_u32 m0, s75, 13312
    s_add_u32 s77, s77, 27648
    buffer_load_dwordx4 v240, s[12:15], s77 offen  lds
    s_add_u32 m0, s75, 14336
    s_add_u32 s77, s77, 27648
    buffer_load_dwordx4 v247, s[12:15], s77 offen  lds
    s_add_u32 m0, s75, 15360
    s_add_u32 s77, s77, 27648
    buffer_load_dwordx4 v247, s[12:15], s77 offen  lds
    v_mov_b32 v14, 0
    buffer_load_dword v15, v14, s[28:31], 0 offen sc0 sc1
    s_add_u32 m0, s75, 16384
    s_mul_i32 s77, s82, 884736
    buffer_load_dwordx4 v240, s[12:15], s77 offen  lds
    s_add_u32 m0, s75, 17408
    s_add_u32 s77, s77, 27648
    buffer_load_dwordx4 v240, s[12:15], s77 offen  lds
    s_add_u32 m0, s75, 18432
    s_add_u32 s77, s77, 27648
    buffer_load_dwordx4 v247, s[12:15], s77 offen  lds
    s_add_u32 m0, s75, 19456
    s_add_u32 s77, s77, 27648
    buffer_load_dwordx4 v247, s[12:15], s77 offen  lds
    s_add_u32 m0, s75, 20480
    s_add_u32 s77, s77, 27648
    buffer_load_dwordx4 v240, s[12:15], s77 offen  lds
    s_add_u32 m0, s75, 21504
    s_add_u32 s77, s77, 27648
    buffer_load_dwordx4 v240, s[12:15], s77 offen  lds
    s_add_u32 m0, s75, 22528
    s_add_u32 s77, s77, 27648
    buffer_load_dwordx4 v247, s[12:15], s77 offen  lds
    s_add_u32 m0, s75, 23552
    s_add_u32 s77, s77, 27648
    buffer_load_dwordx4 v247, s[12:15], s77 offen  lds
    s_waitcnt vmcnt(9)
    s_mov_b64 exec, 1
    v_mov_b32 v12, 160768
    v_mov_b32 v13, 1
    ds_add_u32 v12, v13 offset:8
    s_mov_b64 exec, -1
    s_waitcnt vmcnt(8)
    s_mov_b32 s48, 0
nonce_23:
    v_readfirstlane_b32 s40, v15
    s_nop 1
    s_cmp_lg_u32 s40, 0
    s_cbranch_scc1 nonced_24
    buffer_load_dword v15, v14, s[28:31], 0 offen sc0 sc1
    s_waitcnt vmcnt(0)
    s_add_u32 s48, s48, 1
    s_cmp_lt_u32 s48, 2097152
    s_cbranch_scc1 nonce_23
nonced_24:
    s_and_b32 s98, s40, 0xff
    s_bfe_u32 s41, s40, 0x80008
    s_bfe_u32 s42, s40, 0x80010
    s_lshr_b32 s43, s40, 24
    v_mov_b32 v12, 160768
    s_mov_b32 s48, 0
ldsw_25:
    ds_read_b32 v13, v12 offset:12
    s_waitcnt lgkmcnt(0)
    v_readfirstlane_b32 s60, v13
    s_nop 1
    s_cmp_ge_u32 s60, 4
    s_cbranch_scc1 ldsd_26
    s_sleep 1
    s_add_u32 s48, s48, 1
    s_cmp_lt_u32 s48, 2097152
    s_cbranch_scc1 ldsw_25
ldsd_26:
    s_add_u32 m0, s75, 0
    s_mul_i32 s77, s83, 884736
    buffer_load_dwordx4 v240, s[12:15], s77 offen  lds
    s_add_u32 m0, s75, 1024
    s_add_u32 s77, s77, 27648
    buffer_load_dwordx4 v240, s[12:15], s77 offen  lds
    s_add_u32 m0, s75, 2048
    s_add_u32 s77, s77, 27648
    buffer_load_dwordx4 v247, s[12:15], s77 offen  lds
    s_add_u32 m0, s75, 3072
    s_add_u32 s77, s77, 27648
    buffer_load_dwordx4 v247, s[12:15], s77 offen  lds
    s_add_u32 m0, s75, 4096
    s_add_u32 s77, s77, 27648
    buffer_load_dwordx4 v240, s[12:15], s77 offen  lds
    s_add_u32 m0, s75, 5120
    s_add_u32 s77, s77, 27648
    buffer_load_dwordx4 v240, s[12:15], s77 offen  lds
    s_add_u32 m0, s75, 6144
    s_add_u32 s77, s77, 27648
    buffer_load_dwordx4 v247, s[12:15], s77 offen  lds
    s_add_u32 m0, s75, 7168
    s_add_u32 s77, s77, 27648
    buffer_load_dwordx4 v247, s[12:15], s77 offen  lds
    v_mov_b32 v12, 160768
    v_lshl_add_u32 v12, s37, 2, v12
    s_mov_b32 s48, 0
ldsw_27:
    ds_read_b32 v13, v12 offset:32
    s_waitcnt lgkmcnt(0)
    v_readfirstlane_b32 s60, v13
    s_nop 1
    s_cmp_ge_u32 s60, 1
    s_cbranch_scc1 ldsd_28
    s_sleep 1
    s_add_u32 s48, s48, 1
    s_cmp_lt_u32 s48, 2097152
    s_cbranch_scc1 ldsw_27
ldsd_28:
    s_add_u32 m0, s76, 98304
    s_lshl_b32 s77, s80, 8
    buffer_load_dwordx4 v241, s[32:35], s77 offen sc1 lds
    s_add_u32 m0, s76, 99328
    s_nop 0
    buffer_load_dwordx4 v242, s[32:35], s77 offen sc1 lds
    s_add_u32 m0, s76, 100352
    s_nop 0
    buffer_load_dwordx4 v243, s[32:35], s77 offen sc1 lds
    s_add_u32 m0, s76, 101376
    s_nop 0
    buffer_load_dwordx4 v244, s[32:35], s77 offen sc1 lds
    s_add_u32 m0, s76, 114688
    s_lshl_b32 s77, s81, 8
    buffer_load_dwordx4 v241, s[32:35], s77 offen sc1 lds
    s_add_u32 m0, s76, 115712
    s_nop 0
    buffer_load_dwordx4 v242, s[32:35], s77 offen sc1 lds
    s_add_u32 m0, s76, 116736
    s_nop 0
    buffer_load_dwordx4 v243, s[32:35], s77 offen sc1 lds
    s_add_u32 m0, s76, 117760
    s_nop 0
    buffer_load_dwordx4 v244, s[32:35], s77 offen sc1 lds
    s_waitcnt vmcnt(4)
    s_barrier
    s_add_u32 m0, s76, 131072
    s_lshl_b32 s77, s82, 8
    buffer_load_dwordx4 v241, s[32:35], s77 offen sc1 lds
    s_add_u32 m0, s76, 132096
    s_nop 0
    buffer_load_dwordx4 v242, s[32:35], s77 offen sc1 lds
    s_add_u32 m0, s76, 133120
    s_nop 0
    buffer_load_dwordx4 v243, s[32:35], s77 offen sc1 lds
    s_add_u32 m0, s76, 134144
    s_nop 0
    buffer_load_dwordx4 v244, s[32:35], s77 offen sc1 lds
    s_waitcnt vmcnt(4)
L_ljoin:
    v_min_u32 v249, 17, v2
    v_cmp_lt_u32 vcc, 8, v249
    v_subrev_u32 v255, 9, v249
    s_nop 0
    v_cndmask_b32 v249, v249, v255, vcc
    v_mul_u32_u24 v249, 9, v249
    s_mul_i32 s60, s50, 48
    s_add_u32 s61, s60, 47
    s_lshr_b32 s60, s60, 7
    s_lshr_b32 s61, s61, 7
    v_mov_b32 v254, s60
    v_mov_b32 v255, s61
    v_cndmask_b32 v255, v254, v255, vcc
    v_add_u32 v249, v249, v255
    v_lshlrev_b32 v249, 7, v249
    s_mul_i32 s78, s37, 10368
    s_add_u32 s78, s78, 9154560
    s_mul_i32 s55, s50, 36
    s_mul_i32 s60, s37, 9
    s_add_u32 s55, s55, s60
    s_mul_i32 s55, s55, 3072
    s_add_u32 s55, s55, 4849664
    s_mov_b32 s92, s93
    s_barrier
    s_add_u32 m0, s76, 98304
    s_lshl_b32 s77, s83, 8
    buffer_load_dwordx4 v241, s[32:35], s77 offen sc1 lds
    s_add_u32 m0, s76, 99328
    s_nop 0
    buffer_load_dwordx4 v242, s[32:35], s77 offen sc1 lds
    s_add_u32 m0, s76, 100352
    s_nop 0
    buffer_load_dwordx4 v243, s[32:35], s77 offen sc1 lds
    s_add_u32 m0, s76, 101376
    s_nop 0
    buffer_load_dwordx4 v244, s[32:35], s77 offen sc1 lds
    s_add_u32 m0, s75, 8192
    s_mul_i32 s77, s84, 884736
    buffer_load_dwordx4 v240, s[12:15], s77 offen  lds
    s_add_u32 m0, s75, 9216
    s_add_u32 s77, s77, 27648
    buffer_load_dwordx4 v240, s[12:15], s77 offen  lds
    s_add_u32 m0, s75, 10240
    s_add_u32 s77, s77, 27648
    buffer_load_dwordx4 v247, s[12:15], s77 offen  lds
    s_add_u32 m0, s75, 11264
    s_add_u32 s77, s77, 27648
    buffer_load_dwordx4 v247, s[12:15], s77 offen  lds
    s_add_u32 m0, s75, 12288
    s_add_u32 s77, s77, 27648
    buffer_load_dwordx4 v240, s[12:15], s77 offen  lds
    s_add_u32 m0, s75, 13312
    s_add_u32 s77, s77, 27648
    buffer_load_dwordx4 v240, s[12:15], s77 offen  lds
    s_add_u32 m0, s75, 14336
    s_add_u32 s77, s77, 27648
    buffer_load_dwordx4 v247, s[12:15], s77 offen  lds
    s_add_u32 m0, s75, 15360
    s_add_u32 s77, s77, 27648
    buffer_load_dwordx4 v247, s[12:15], s77 offen  lds
    s_waitcnt vmcnt(12)
    s_barrier
    s_add_u32 m0, s76, 114688
    s_lshl_b32 s77, s84, 8
    buffer_load_dwordx4 v241, s[32:35], s77 offen sc1 lds
    s_add_u32 m0, s76, 115712
    s_nop 0
    buffer_load_dwordx4 v242, s[32:35], s77 offen sc1 lds
    s_add_u32 m0, s76, 116736
    s_nop 0
    buffer_load_dwordx4 v243, s[32:35], s77 offen sc1 lds
    s_add_u32 m0, s76, 117760
    s_nop 0
    buffer_load_dwordx4 v244, s[32:35], s77 offen sc1 lds
    s_add_u32 m0, s75, 16384
    s_mul_i32 s77, s85, 884736
    buffer_load_dwordx4 v240, s[12:15], s77 offen  lds
    s_add_u32 m0, s75, 17408
    s_add_u32 s77, s77, 27648
    buffer_load_dwordx4 v240, s[12:15], s77 offen  lds
    s_add_u32 m0, s75, 18432
    s_add_u32 s77, s77, 27648
    buffer_load_dwordx4 v247, s[12:15], s77 offen  lds
    s_add_u32 m0, s75, 19456
    s_add_u32 s77, s77, 27648
    buffer_load_dwordx4 v247, s[12:15], s77 offen  lds
    s_add_u32 m0, s75, 20480
    s_add_u32 s77, s77, 27648
    buffer_load_dwordx4 v240, s[12:15], s77 offen  lds
    s_add_u32 m0, s75, 21504
    s_add_u32 s77, s77, 27648
    buffer_load_dwordx4 v240, s[12:15], s77 offen  lds
    s_add_u32 m0, s75, 22528
    s_add_u32 s77, s77, 27648
    buffer_load_dwordx4 v247, s[12:15], s77 offen  lds
    s_add_u32 m0, s75, 23552
    s_add_u32 s77, s77, 27648
    buffer_load_dwordx4 v247, s[12:15], s77 offen  lds
    s_waitcnt vmcnt(12)
    s_barrier
    s_add_u32 m0, s76, 131072
    s_lshl_b32 s77, s85, 8
    buffer_load_dwordx4 v241, s[32:35], s77 offen sc1 lds
    s_add_u32 m0, s76, 132096
    s_nop 0
    buffer_load_dwordx4 v242, s[32:35], s77 offen sc1 lds
    s_add_u32 m0, s76, 133120
    s_nop 0
    buffer_load_dwordx4 v243, s[32:35], s77 offen sc1 lds
    s_add_u32 m0, s76, 134144
    s_nop 0
    buffer_load_dwordx4 v244, s[32:35], s77 offen sc1 lds
    s_add_u32 m0, s75, 0
    s_mul_i32 s77, s86, 884736
    buffer_load_dwordx4 v240, s[12:15], s77 offen  lds
    s_add_u32 m0, s75, 1024
    s_add_u32 s77, s77, 27648
    buffer_load_dwordx4 v240, s[12:15], s77 offen  lds
    s_add_u32 m0, s75, 2048
    s_add_u32 s77, s77, 27648
    buffer_load_dwordx4 v247, s[12:15], s77 offen  lds
    s_add_u32 m0, s75, 3072
    s_add_u32 s77, s77, 27648
    buffer_load_dwordx4 v247, s[12:15], s77 offen  lds
    s_add_u32 m0, s75, 4096
    s_add_u32 s77, s77, 27648
    buffer_load_dwordx4 v240, s[12:15], s77 offen  lds
    s_add_u32 m0, s75, 5120
    s_add_u32 s77, s77, 27648
    buffer_load_dwordx4 v240, s[12:15], s77 offen  lds
    s_add_u32 m0, s75, 6144
    s_add_u32 s77, s77, 27648
    buffer_load_dwordx4 v247, s[12:15], s77 offen  lds
    s_add_u32 m0, s75, 7168
    s_add_u32 s77, s77, 27648
    buffer_load_dwordx4 v247, s[12:15], s77 offen  lds
    s_waitcnt vmcnt(12)
    s_barrier
    s_add_u32 m0, s76, 98304
    s_lshl_b32 s77, s86, 8
    buffer_load_dwordx4 v241, s[32:35], s77 offen sc1 lds
    s_add_u32 m0, s76, 99328
    s_nop 0
    buffer_load_dwordx4 v242, s[32:35], s77 offen sc1 lds
    s_add_u32 m0, s76, 100352
    s_nop 0
    buffer_load_dwordx4 v243, s[32:35], s77 offen sc1 lds
    s_add_u32 m0, s76, 101376
    s_nop 0
    buffer_load_dwordx4 v244, s[32:35], s77 offen sc1 lds
    s_add_u32 m0, s75, 8192
    s_mul_i32 s77, s87, 884736
    buffer_load_dwordx4 v240, s[12:15], s77 offen  lds
    s_add_u32 m0, s75, 9216
    s_add_u32 s77, s77, 27648
    buffer_load_dwordx4 v240, s[12:15], s77 offen  lds
    s_add_u32 m0, s75, 10240
    s_add_u32 s77, s77, 27648
    buffer_load_dwordx4 v247, s[12:15], s77 offen  lds
    s_add_u32 m0, s75, 11264
    s_add_u32 s77, s77, 27648
    buffer_load_dwordx4 v247, s[12:15], s77 offen  lds
    s_add_u32 m0, s75, 12288
    s_add_u32 s77, s77, 27648
    buffer_load_dwordx4 v240, s[12:15], s77 offen  lds
    s_add_u32 m0, s75, 13312
    s_add_u32 s77, s77, 27648
    buffer_load_dwordx4 v240, s[12:15], s77 offen  lds
    s_add_u32 m0, s75, 14336
    s_add_u32 s77, s77, 27648
    buffer_load_dwordx4 v247, s[12:15], s77 offen  lds
    s_add_u32 m0, s75, 15360
    s_add_u32 s77, s77, 27648
    buffer_load_dwordx4 v247, s[12:15], s77 offen  lds
    s_waitcnt vmcnt(12)
    s_barrier
    s_add_u32 m0, s76, 114688
    s_lshl_b32 s77, s87, 8
    buffer_load_dwordx4 v241, s[32:35], s77 offen sc1 lds
    s_add_u32 m0, s76, 115712
    s_nop 0
    buffer_load_dwordx4 v242, s[32:35], s77 offen sc1 lds
    s_add_u32 m0, s76, 116736
    s_nop 0
    buffer_load_dwordx4 v243, s[32:35], s77 offen sc1 lds
    s_add_u32 m0, s76, 117760
    s_nop 0
    buffer_load_dwordx4 v244, s[32:35], s77 offen sc1 lds
    s_add_u32 m0, s75, 16384
    s_mul_i32 s77, s88, 884736
    buffer_load_dwordx4 v240, s[12:15], s77 offen  lds
    s_add_u32 m0, s75, 17408
    s_add_u32 s77, s77, 27648
    buffer_load_dwordx4 v240, s[12:15], s77 offen  lds
    s_add_u32 m0, s75, 18432
    s_add_u32 s77, s77, 27648
    buffer_load_dwordx4 v247, s[12:15], s77 offen  lds
    s_add_u32 m0, s75, 19456
    s_add_u32 s77, s77, 27648
    buffer_load_dwordx4 v247, s[12:15], s77 offen  lds
    s_add_u32 m0, s75, 20480
    s_add_u32 s77, s77, 27648
    buffer_load_dwordx4 v240, s[12:15], s77 offen  lds
    s_add_u32 m0, s75, 21504
    s_add_u32 s77, s77, 27648
    buffer_load_dwordx4 v240, s[12:15], s77 offen  lds
    s_add_u32 m0, s75, 22528
    s_add_u32 s77, s77, 27648
    buffer_load_dwordx4 v247, s[12:15], s77 offen  lds
    s_add_u32 m0, s75, 23552
    s_add_u32 s77, s77, 27648
    buffer_load_dwordx4 v247, s[12:15], s77 offen  lds
    s_waitcnt vmcnt(12)
    s_barrier
    s_add_u32 m0, s76, 131072
    s_lshl_b32 s77, s88, 8
    buffer_load_dwordx4 v241, s[32:35], s77 offen sc1 lds
    s_add_u32 m0, s76, 132096
    s_nop 0
    buffer_load_dwordx4 v242, s[32:35], s77 offen sc1 lds
    s_add_u32 m0, s76, 133120
    s_nop 0
    buffer_load_dwordx4 v243, s[32:35], s77 offen sc1 lds
    s_add_u32 m0, s76, 134144
    s_nop 0
    buffer_load_dwordx4 v244, s[32:35], s77 offen sc1 lds
    buffer_load_dword v248, v249, s[32:35], s78 offen sc0 sc1
    s_waitcnt vmcnt(5)
    s_barrier
    s_waitcnt vmcnt(0)
    v_cmp_ne_u32 vcc, s40, v248
    s_nop 1
    s_cmp_eq_u64 vcc, 0
    s_cselect_b32 s79, 1, 0
    s_cmp_lt_u32 s39, 24
    s_cselect_b32 s79, s79, 0
    s_cmp_eq_u32 s79, 0
    s_cbranch_scc1 nowo_29
    s_mul_i32 s91, s92, 3072
    s_add_u32 s91, s91, s55
    buffer_load_dwordx4 v[8:11], v5, s[32:35], s91 offen offset:0 sc1
    buffer_load_dwordx4 v[12:15], v5, s[32:35], s91 offen offset:1024 sc1
    buffer_load_dwordx4 v[16:19], v5, s[32:35], s91 offen offset:2048 sc1
    s_add_u32 s92, s92, 1
    s_cmp_eq_u32 s92, 9
    s_cselect_b32 s92, 0, s92
    s_mul_i32 s91, s92, 3072
    s_add_u32 s91, s91, s55
    buffer_load_dwordx4 v[20:23], v5, s[32:35], s91 offen offset:0 sc1
    buffer_load_dwordx4 v[24:27], v5, s[32:35], s91 offen offset:1024 sc1
    s_waitcnt vmcnt(5)
    s_branch wojoin_30
nowo_29:
    s_waitcnt vmcnt(0)
wojoin_30:
    s_barrier
    s_cmp_eq_u32 s79, 0
    s_cbranch_scc1 nowo_31
    buffer_load_dwordx4 v[28:31], v5, s[32:35], s91 offen offset:2048 sc1
    s_add_u32 s92, s92, 1
    s_cmp_eq_u32 s92, 9
    s_cselect_b32 s92, 0, s92
    s_mul_i32 s91, s92, 3072
    s_add_u32 s91, s91, s55
    buffer_load_dwordx4 v[32:35], v5, s[32:35], s91 offen offset:0 sc1
    buffer_load_dwordx4 v[36:39], v5, s[32:35], s91 offen offset:1024 sc1
    buffer_load_dwordx4 v[40:43], v5, s[32:35], s91 offen offset:2048 sc1
    s_add_u32 s92, s92, 1
    s_cmp_eq_u32 s92, 9
    s_cselect_b32 s92, 0, s92
    s_mul_i32 s91, s92, 3072
    s_add_u32 s91, s91, s55
    buffer_load_dwordx4 v[44:47], v5, s[32:35], s91 offen offset:0 sc1
    buffer_load_dwordx4 v[48:51], v5, s[32:35], s91 offen offset:1024 sc1
    buffer_load_dwordx4 v[52:55], v5, s[32:35], s91 offen offset:2048 sc1
    s_add_u32 s92, s92, 1
    s_cmp_eq_u32 s92, 9
    s_cselect_b32 s92, 0, s92
    s_mul_i32 s91, s92, 3072
    s_add_u32 s91, s91, s55
    buffer_load_dwordx4 v[56:59], v5, s[32:35], s91 offen offset:0 sc1
    buffer_load_dwordx4 v[60:63], v5, s[32:35], s91 offen offset:1024 sc1
    buffer_load_dwordx4 v[64:67], v5, s[32:35], s91 offen offset:2048 sc1
    s_add_u32 s92, s92, 1
    s_cmp_eq_u32 s92, 9
    s_cselect_b32 s92, 0, s92
    s_mul_i32 s91, s92, 3072
    s_add_u32 s91, s91, s55
    buffer_load_dwordx4 v[68:71], v5, s[32:35], s91 offen offset:0 sc1
    buffer_load_dwordx4 v[72:75], v5, s[32:35], s91 offen offset:1024 sc1
    buffer_load_dwordx4 v[76:79], v5, s[32:35], s91 offen offset:2048 sc1
    s_add_u32 s92, s92, 1
    s_cmp_eq_u32 s92, 9
    s_cselect_b32 s92, 0, s92
    s_mul_i32 s91, s92, 3072
    s_add_u32 s91, s91, s55
    buffer_load_dwordx4 v[80:83], v5, s[32:35], s91 offen offset:0 sc1
    buffer_load_dwordx4 v[84:87], v5, s[32:35], s91 offen offset:1024 sc1
    buffer_load_dwordx4 v[88:91], v5, s[32:35], s91 offen offset:2048 sc1
    s_add_u32 s92, s92, 1
    s_cmp_eq_u32 s92, 9
    s_cselect_b32 s92, 0, s92
    s_mul_i32 s91, s92, 3072
    s_add_u32 s91, s91, s55
    buffer_load_dwordx4 v[92:95], v5, s[32:35], s91 offen offset:0 sc1
    buffer_load_dwordx4 v[96:99], v5, s[32:35], s91 offen offset:1024 sc1
    buffer_load_dwordx4 v[100:103], v5, s[32:35], s91 offen offset:2048 sc1
    s_add_u32 s92, s92, 1
    s_cmp_eq_u32 s92, 9
    s_cselect_b32 s92, 0, s92
    s_mul_i32 s91, s92, 3072
    s_add_u32 s91, s91, s55
    buffer_load_dwordx4 v[104:107], v5, s[32:35], s91 offen offset:0 sc1
    buffer_load_dwordx4 v[108:111], v5, s[32:35], s91 offen offset:1024 sc1
    buffer_load_dwordx4 v[112:115], v5, s[32:35], s91 offen offset:2048 sc1
nowo_31:
    s_barrier
    s_cmp_ge_u32 s39, 24
    s_cbranch_scc1 L_s_l
    v_and_b32 v252, 7, v2
    v_min_u32 v252, 4, v252
    v_bfe_u32 v253, v2, 3, 1
    v_mad_u32_u24 v252, v253, 18, v252
    v_lshlrev_b32 v252, 7, v252
    s_mul_i32 s61, s49, 36
    s_mul_i32 s62, s37, 9
    s_lshr_b32 s60, s62, 1
    s_add_u32 s61, s61, s60
    s_lshl_b32 s61, s61, 7
    s_add_u32 s61, s61, 9052160
    s_mul_i32 s63, s49, 144
    s_add_u32 s63, s63, s62
    s_lshl_b32 s63, s63, 10
    s_add_u32 s63, s63, 3670016
    s_add_u32 s64, s63, 36864
    s_add_u32 s65, s63, 73728
    s_add_u32 s66, s63, 110592
    s_mul_i32 s60, s37, 12288
    s_add_u32 s60, s60, 73728
    v_add_u32 v7, s60, v5
    s_cmp_lg_u32 s79, 0
    s_cbranch_scc1 worest_33
    s_mov_b32 s48, 0
poll_34:
    buffer_load_dword v253, v249, s[32:35], s78 offen sc0 sc1
    s_waitcnt vmcnt(0)
    v_cmp_ne_u32 vcc, s40, v253
    s_cbranch_vccz polld_35
    s_nop 0
    s_mov_b64 exec, vcc
    s_sleep 1
    s_add_u32 s48, s48, 1
    s_cmp_lt_u32 s48, 2097152
    s_cbranch_scc1 poll_34
polld_35:
    s_mov_b64 exec, -1
    s_mul_i32 s91, s92, 3072
    s_add_u32 s91, s91, s55
    buffer_load_dwordx4 v[8:11], v5, s[32:35], s91 offen offset:0 sc1
    buffer_load_dwordx4 v[12:15], v5, s[32:35], s91 offen offset:1024 sc1
    buffer_load_dwordx4 v[16:19], v5, s[32:35], s91 offen offset:2048 sc1
    s_add_u32 s92, s92, 1
    s_cmp_eq_u32 s92, 9
    s_cselect_b32 s92, 0, s92
    s_mul_i32 s91, s92, 3072
    s_add_u32 s91, s91, s55
    buffer_load_dwordx4 v[20:23], v5, s[32:35], s91 offen offset:0 sc1
    buffer_load_dwordx4 v[24:27], v5, s[32:35], s91 offen offset:1024 sc1
    buffer_load_dwordx4 v[28:31], v5, s[32:35], s91 offen offset:2048 sc1
    s_add_u32 s92, s92, 1
    s_cmp_eq_u32 s92, 9
    s_cselect_b32 s92, 0, s92
    s_mul_i32 s91, s92, 3072
    s_add_u32 s91, s91, s55
    buffer_load_dwordx4 v[32:35], v5, s[32:35], s91 offen offset:0 sc1
    buffer_load_dwordx4 v[36:39], v5, s[32:35], s91 offen offset:1024 sc1
    buffer_load_dwordx4 v[40:43], v5, s[32:35], s91 offen offset:2048 sc1
    s_add_u32 s92, s92, 1
    s_cmp_eq_u32 s92, 9
    s_cselect_b32 s92, 0, s92
    s_mul_i32 s91, s92, 3072
    s_add_u32 s91, s91, s55
    buffer_load_dwordx4 v[44:47], v5, s[32:35], s91 offen offset:0 sc1
    buffer_load_dwordx4 v[48:51], v5, s[32:35], s91 offen offset:1024 sc1
    buffer_load_dwordx4 v[52:55], v5, s[32:35], s91 offen offset:2048 sc1
    s_add_u32 s92, s92, 1
    s_cmp_eq_u32 s92, 9
    s_cselect_b32 s92, 0, s92
    s_mul_i32 s91, s92, 3072
    s_add_u32 s91, s91, s55
    buffer_load_dwordx4 v[56:59], v5, s[32:35], s91 offen offset:0 sc1
    buffer_load_dwordx4 v[60:63], v5, s[32:35], s91 offen offset:1024 sc1
    buffer_load_dwordx4 v[64:67], v5, s[32:35], s91 offen offset:2048 sc1
    s_add_u32 s92, s92, 1
    s_cmp_eq_u32 s92, 9
    s_cselect_b32 s92, 0, s92
    s_mul_i32 s91, s92, 3072
    s_add_u32 s91, s91, s55
    buffer_load_dwordx4 v[68:71], v5, s[32:35], s91 offen offset:0 sc1
    buffer_load_dwordx4 v[72:75], v5, s[32:35], s91 offen offset:1024 sc1
    buffer_load_dwordx4 v[76:79], v5, s[32:35], s91 offen offset:2048 sc1
    s_add_u32 s92, s92, 1
    s_cmp_eq_u32 s92, 9
    s_cselect_b32 s92, 0, s92
    s_mul_i32 s91, s92, 3072
    s_add_u32 s91, s91, s55
    buffer_load_dwordx4 v[80:83], v5, s[32:35], s91 offen offset:0 sc1
    buffer_load_dwordx4 v[84:87], v5, s[32:35], s91 offen offset:1024 sc1
    buffer_load_dwordx4 v[88:91], v5, s[32:35], s91 offen offset:2048 sc1
    s_add_u32 s92, s92, 1
    s_cmp_eq_u32 s92, 9
    s_cselect_b32 s92, 0, s92
    s_mul_i32 s91, s92, 3072
    s_add_u32 s91, s91, s55
    buffer_load_dwordx4 v[92:95], v5, s[32:35], s91 offen offset:0 sc1
    buffer_load_dwordx4 v[96:99], v5, s[32:35], s91 offen offset:1024 sc1
    buffer_load_dwordx4 v[100:103], v5, s[32:35], s91 offen offset:2048 sc1
    s_add_u32 s92, s92, 1
    s_cmp_eq_u32 s92, 9
    s_cselect_b32 s92, 0, s92
    s_mul_i32 s91, s92, 3072
    s_add_u32 s91, s91, s55
    buffer_load_dwordx4 v[104:107], v5, s[32:35], s91 offen offset:0 sc1
    buffer_load_dwordx4 v[108:111], v5, s[32:35], s91 offen offset:1024 sc1
    buffer_load_dwordx4 v[112:115], v5, s[32:35], s91 offen offset:2048 sc1
worest_33:
    s_barrier
    s_mov_b32 s48, 0
    s_mov_b64 exec, 1
poll1_38:
    buffer_load_dword v253, v252, s[32:35], s61 offen sc0 sc1
    s_waitcnt vmcnt(0)
    v_cmp_ne_u32 vcc, s40, v253
    s_cbranch_vccz poll1d_39
    s_sleep 8
    s_add_u32 s48, s48, 1
    s_cmp_lt_u32 s48, 2097152
    s_cbranch_scc1 poll1_38
poll1d_39:
    s_mov_b64 exec, -1
poll_36:
    buffer_load_dword v253, v252, s[32:35], s61 offen sc0 sc1
    s_waitcnt vmcnt(0)
    v_cmp_ne_u32 vcc, s40, v253
    s_cbranch_vccz polld_37
    s_nop 0
    s_mov_b64 exec, vcc
    s_sleep 1
    s_add_u32 s48, s48, 1
    s_cmp_lt_u32 s48, 2097152
    s_cbranch_scc1 poll_36
polld_37:
    s_mov_b64 exec, -1
    v_lshl_add_u32 v6, s93, 10, v5
    buffer_load_dwordx4 v[164:167], v6, s[32:35], s63 offen sc1
    buffer_load_dwordx4 v[168:171], v6, s[32:35], s64 offen sc1
    buffer_load_dwordx4 v[172:175], v6, s[32:35], s65 offen sc1
    buffer_load_dwordx4 v[176:179], v6, s[32:35], s66 offen sc1
    s_add_u32 s93, s93, 1
    s_cmp_eq_u32 s93, 9
    s_cselect_b32 s93, 0, s93
    v_lshl_add_u32 v6, s93, 10, v5
    buffer_load_dwordx4 v[180:183], v6, s[32:35], s63 offen sc1
    buffer_load_dwordx4 v[184:187], v6, s[32:35], s64 offen sc1
    buffer_load_dwordx4 v[188:191], v6, s[32:35], s65 offen sc1
    buffer_load_dwordx4 v[192:195], v6, s[32:35], s66 offen sc1
    s_add_u32 s93, s93, 1
    s_cmp_eq_u32 s93, 9
    s_cselect_b32 s93, 0, s93
    v_lshl_add_u32 v6, s93, 10, v5
    buffer_load_dwordx4 v[196:199], v6, s[32:35], s63 offen sc1
    buffer_load_dwordx4 v[200:203], v6, s[32:35], s64 offen sc1
    buffer_load_dwordx4 v[204:207], v6, s[32:35], s65 offen sc1
    buffer_load_dwordx4 v[208:211], v6, s[32:35], s66 offen sc1
    s_add_u32 s93, s93, 1
    s_cmp_eq_u32 s93, 9
    s_cselect_b32 s93, 0, s93
    v_lshl_add_u32 v6, s93, 10, v5
    buffer_load_dwordx4 v[212:215], v6, s[32:35], s63 offen sc1
    buffer_load_dwordx4 v[216:219], v6, s[32:35], s64 offen sc1
    buffer_load_dwordx4 v[220:223], v6, s[32:35], s65 offen sc1
    buffer_load_dwordx4 v[224:227], v6, s[32:35], s66 offen sc1
    s_add_u32 s93, s93, 1
    s_cmp_eq_u32 s93, 9
    s_cselect_b32 s93, 0, s93
    v_lshl_add_u32 v6, s93, 10, v5
    buffer_load_dwordx4 v[228:231], v6, s[32:35], s63 offen sc1
    buffer_load_dwordx4 v[232:235], v6, s[32:35], s64 offen sc1
    buffer_load_dwordx4 v[236:239], v6, s[32:35], s65 offen sc1
    buffer_load_dwordx4 v[240:243], v6, s[32:35], s66 offen sc1
    s_add_u32 s93, s93, 1
    s_cmp_eq_u32 s93, 9
    s_cselect_b32 s93, 0, s93
    s_waitcnt vmcnt(19)
    v_mfma_f32_16x16x32_bf16 v[116:119], v[164:167], v[8:11], 0
    v_mfma_f32_16x16x32_bf16 v[120:123], v[164:167], v[12:15], 0
    v_mfma_f32_16x16x32_bf16 v[124:127], v[164:167], v[16:19], 0
    s_waitcnt vmcnt(18)
    v_mfma_f32_16x16x32_bf16 v[128:131], v[168:171], v[8:11], 0
    v_mfma_f32_16x16x32_bf16 v[132:135], v[168:171], v[12:15], 0
    v_mfma_f32_16x16x32_bf16 v[136:139], v[168:171], v[16:19], 0
    s_waitcnt vmcnt(17)
    v_mfma_f32_16x16x32_bf16 v[140:143], v[172:175], v[8:11], 0
    v_mfma_f32_16x16x32_bf16 v[144:147], v[172:175], v[12:15], 0
    v_mfma_f32_16x16x32_bf16 v[148:151], v[172:175], v[16:19], 0
    s_waitcnt vmcnt(16)
    v_mfma_f32_16x16x32_bf16 v[152:155], v[176:179], v[8:11], 0
    v_mfma_f32_16x16x32_bf16 v[156:159], v[176:179], v[12:15], 0
    v_mfma_f32_16x16x32_bf16 v[160:163], v[176:179], v[16:19], 0
    v_lshl_add_u32 v6, s93, 10, v5
    buffer_load_dwordx4 v[164:167], v6, s[32:35], s63 offen sc1
    buffer_load_dwordx4 v[168:171], v6, s[32:35], s64 offen sc1
    buffer_load_dwordx4 v[172:175], v6, s[32:35], s65 offen sc1
    buffer_load_dwordx4 v[176:179], v6, s[32:35], s66 offen sc1
    s_add_u32 s93, s93, 1
    s_cmp_eq_u32 s93, 9
    s_cselect_b32 s93, 0, s93
    s_waitcnt vmcnt(19)
    v_mfma_f32_16x16x32_bf16 v[116:119], v[180:183], v[20:23], v[116:119]
    v_mfma_f32_16x16x32_bf16 v[120:123], v[180:183], v[24:27], v[120:123]
    v_mfma_f32_16x16x32_bf16 v[124:127], v[180:183], v[28:31], v[124:127]
    s_waitcnt vmcnt(18)
    v_mfma_f32_16x16x32_bf16 v[128:131], v[184:187], v[20:23], v[128:131]
    v_mfma_f32_16x16x32_bf16 v[132:135], v[184:187], v[24:27], v[132:135]
    v_mfma_f32_16x16x32_bf16 v[136:139], v[184:187], v[28:31], v[136:139]
    s_waitcnt vmcnt(17)
    v_mfma_f32_16x16x32_bf16 v[140:143], v[188:191], v[20:23], v[140:143]
    v_mfma_f32_16x16x32_bf16 v[144:147], v[188:191], v[24:27], v[144:147]
    v_mfma_f32_16x16x32_bf16 v[148:151], v[188:191], v[28:31], v[148:151]
    s_waitcnt vmcnt(16)
    v_mfma_f32_16x16x32_bf16 v[152:155], v[192:195], v[20:23], v[152:155]
    v_mfma_f32_16x16x32_bf16 v[156:159], v[192:195], v[24:27], v[156:159]
    v_mfma_f32_16x16x32_bf16 v[160:163], v[192:195], v[28:31], v[160:163]
    v_lshl_add_u32 v6, s93, 10, v5
    buffer_load_dwordx4 v[180:183], v6, s[32:35], s63 offen sc1
    buffer_load_dwordx4 v[184:187], v6, s[32:35], s64 offen sc1
    buffer_load_dwordx4 v[188:191], v6, s[32:35], s65 offen sc1
    buffer_load_dwordx4 v[192:195], v6, s[32:35], s66 offen sc1
    s_add_u32 s93, s93, 1
    s_cmp_eq_u32 s93, 9
    s_cselect_b32 s93, 0, s93
    s_waitcnt vmcnt(19)
    v_mfma_f32_16x16x32_bf16 v[116:119], v[196:199], v[32:35], v[116:119]
    v_mfma_f32_16x16x32_bf16 v[120:123], v[196:199], v[36:39], v[120:123]
    v_mfma_f32_16x16x32_bf16 v[124:127], v[196:199], v[40:43], v[124:127]
    s_waitcnt vmcnt(18)
    v_mfma_f32_16x16x32_bf16 v[128:131], v[200:203], v[32:35], v[128:131]
    v_mfma_f32_16x16x32_bf16 v[132:135], v[200:203], v[36:39], v[132:135]
    v_mfma_f32_16x16x32_bf16 v[136:139], v[200:203], v[40:43], v[136:139]
    s_waitcnt vmcnt(17)
    v_mfma_f32_16x16x32_bf16 v[140:143], v[204:207], v[32:35], v[140:143]
    v_mfma_f32_16x16x32_bf16 v[144:147], v[204:207], v[36:39], v[144:147]
    v_mfma_f32_16x16x32_bf16 v[148:151], v[204:207], v[40:43], v[148:151]
    s_waitcnt vmcnt(16)
    v_mfma_f32_16x16x32_bf16 v[152:155], v[208:211], v[32:35], v[152:155]
    v_mfma_f32_16x16x32_bf16 v[156:159], v[208:211], v[36:39], v[156:159]
    v_mfma_f32_16x16x32_bf16 v[160:163], v[208:211], v[40:43], v[160:163]
    v_lshl_add_u32 v6, s93, 10, v5
    buffer_load_dwordx4 v[196:199], v6, s[32:35], s63 offen sc1
    buffer_load_dwordx4 v[200:203], v6, s[32:35], s64 offen sc1
    buffer_load_dwordx4 v[204:207], v6, s[32:35], s65 offen sc1
    buffer_load_dwordx4 v[208:211], v6, s[32:35], s66 offen sc1
    s_add_u32 s93, s93, 1
    s_cmp_eq_u32 s93, 9
    s_cselect_b32 s93, 0, s93
    s_waitcnt vmcnt(19)
    v_mfma_f32_16x16x32_bf16 v[116:119], v[212:215], v[44:47], v[116:119]
    v_mfma_f32_16x16x32_bf16 v[120:123], v[212:215], v[48:51], v[120:123]
    v_mfma_f32_16x16x32_bf16 v[124:127], v[212:215], v[52:55], v[124:127]
    s_waitcnt vmcnt(18)
    v_mfma_f32_16x16x32_bf16 v[128:131], v[216:219], v[44:47], v[128:131]
    v_mfma_f32_16x16x32_bf16 v[132:135], v[216:219], v[48:51], v[132:135]
    v_mfma_f32_16x16x32_bf16 v[136:139], v[216:219], v[52:55], v[136:139]
    s_waitcnt vmcnt(17)
    v_mfma_f32_16x16x32_bf16 v[140:143], v[220:223], v[44:47], v[140:143]
    v_mfma_f32_16x16x32_bf16 v[144:147], v[220:223], v[48:51], v[144:147]
    v_mfma_f32_16x16x32_bf16 v[148:151], v[220:223], v[52:55], v[148:151]
    s_waitcnt vmcnt(16)
    v_mfma_f32_16x16x32_bf16 v[152:155], v[224:227], v[44:47], v[152:155]
    v_mfma_f32_16x16x32_bf16 v[156:159], v[224:227], v[48:51], v[156:159]
    v_mfma_f32_16x16x32_bf16 v[160:163], v[224:227], v[52:55], v[160:163]
    v_lshl_add_u32 v6, s93, 10, v5
    buffer_load_dwordx4 v[212:215], v6, s[32:35], s63 offen sc1
    buffer_load_dwordx4 v[216:219], v6, s[32:35], s64 offen sc1
    buffer_load_dwordx4 v[220:223], v6, s[32:35], s65 offen sc1
    buffer_load_dwordx4 v[224:227], v6, s[32:35], s66 offen sc1
    s_waitcnt vmcnt(19)
    v_mfma_f32_16x16x32_bf16 v[116:119], v[228:231], v[56:59], v[116:119]
    v_mfma_f32_16x16x32_bf16 v[120:123], v[228:231], v[60:63], v[120:123]
    v_mfma_f32_16x16x32_bf16 v[124:127], v[228:231], v[64:67], v[124:127]
    s_waitcnt vmcnt(18)
    v_mfma_f32_16x16x32_bf16 v[128:131], v[232:235], v[56:59], v[128:131]
    v_mfma_f32_16x16x32_bf16 v[132:135], v[232:235], v[60:63], v[132:135]
    v_mfma_f32_16x16x32_bf16 v[136:139], v[232:235], v[64:67], v[136:139]
    s_waitcnt vmcnt(17)
    v_mfma_f32_16x16x32_bf16 v[140:143], v[236:239], v[56:59], v[140:143]
    v_mfma_f32_16x16x32_bf16 v[144:147], v[236:239], v[60:63], v[144:147]
    v_mfma_f32_16x16x32_bf16 v[148:151], v[236:239], v[64:67], v[148:151]
    s_waitcnt vmcnt(16)
    v_mfma_f32_16x16x32_bf16 v[152:155], v[240:243], v[56:59], v[152:155]
    v_mfma_f32_16x16x32_bf16 v[156:159], v[240:243], v[60:63], v[156:159]
    v_mfma_f32_16x16x32_bf16 v[160:163], v[240:243], v[64:67], v[160:163]
    s_waitcnt vmcnt(15)
    v_mfma_f32_16x16x32_bf16 v[116:119], v[164:167], v[68:71], v[116:119]
    v_mfma_f32_16x16x32_bf16 v[120:123], v[164:167], v[72:75], v[120:123]
    v_mfma_f32_16x16x32_bf16 v[124:127], v[164:167], v[76:79], v[124:127]
    s_waitcnt vmcnt(14)
    v_mfma_f32_16x16x32_bf16 v[128:131], v[168:171], v[68:71], v[128:131]
    v_mfma_f32_16x16x32_bf16 v[132:135], v[168:171], v[72:75], v[132:135]
    v_mfma_f32_16x16x32_bf16 v[136:139], v[168:171], v[76:79], v[136:139]
    s_waitcnt vmcnt(13)
    v_mfma_f32_16x16x32_bf16 v[140:143], v[172:175], v[68:71], v[140:143]
    v_mfma_f32_16x16x32_bf16 v[144:147], v[172:175], v[72:75], v[144:147]
    v_mfma_f32_16x16x32_bf16 v[148:151], v[172:175], v[76:79], v[148:151]
    s_waitcnt vmcnt(12)
    v_mfma_f32_16x16x32_bf16 v[152:155], v[176:179], v[68:71], v[152:155]
    v_mfma_f32_16x16x32_bf16 v[156:159], v[176:179], v[72:75], v[156:159]
    v_mfma_f32_16x16x32_bf16 v[160:163], v[176:179], v[76:79], v[160:163]
    s_waitcnt vmcnt(11)
    v_mfma_f32_16x16x32_bf16 v[116:119], v[180:183], v[80:83], v[116:119]
    v_mfma_f32_16x16x32_bf16 v[120:123], v[180:183], v[84:87], v[120:123]
    v_mfma_f32_16x16x32_bf16 v[124:127], v[180:183], v[88:91], v[124:127]
    s_waitcnt vmcnt(10)
    v_mfma_f32_16x16x32_bf16 v[128:131], v[184:187], v[80:83], v[128:131]
    v_mfma_f32_16x16x32_bf16 v[132:135], v[184:187], v[84:87], v[132:135]
    v_mfma_f32_16x16x32_bf16 v[136:139], v[184:187], v[88:91], v[136:139]
    s_waitcnt vmcnt(9)
    v_mfma_f32_16x16x32_bf16 v[140:143], v[188:191], v[80:83], v[140:143]
    v_mfma_f32_16x16x32_bf16 v[144:147], v[188:191], v[84:87], v[144:147]
    v_mfma_f32_16x16x32_bf16 v[148:151], v[188:191], v[88:91], v[148:151]
    s_waitcnt vmcnt(8)
    v_mfma_f32_16x16x32_bf16 v[152:155], v[192:195], v[80:83], v[152:155]
    v_mfma_f32_16x16x32_bf16 v[156:159], v[192:195], v[84:87], v[156:159]
    v_mfma_f32_16x16x32_bf16 v[160:163], v[192:195], v[88:91], v[160:163]
    s_waitcnt vmcnt(7)
    v_mfma_f32_16x16x32_bf16 v[116:119], v[196:199], v[92:95], v[116:119]
    v_mfma_f32_16x16x32_bf16 v[120:123], v[196:199], v[96:99], v[120:123]
    v_mfma_f32_16x16x32_bf16 v[124:127], v[196:199], v[100:103], v[124:127]
    s_waitcnt vmcnt(6)
    v_mfma_f32_16x16x32_bf16 v[128:131], v[200:203], v[92:95], v[128:131]
    v_mfma_f32_16x16x32_bf16 v[132:135], v[200:203], v[96:99], v[132:135]
    v_mfma_f32_16x16x32_bf16 v[136:139], v[200:203], v[100:103], v[136:139]
    s_waitcnt vmcnt(5)
    v_mfma_f32_16x16x32_bf16 v[140:143], v[204:207], v[92:95], v[140:143]
    v_mfma_f32_16x16x32_bf16 v[144:147], v[204:207], v[96:99], v[144:147]
    v_mfma_f32_16x16x32_bf16 v[148:151], v[204:207], v[100:103], v[148:151]
    s_waitcnt vmcnt(4)
    v_mfma_f32_16x16x32_bf16 v[152:155], v[208:211], v[92:95], v[152:155]
    v_mfma_f32_16x16x32_bf16 v[156:159], v[208:211], v[96:99], v[156:159]
    v_mfma_f32_16x16x32_bf16 v[160:163], v[208:211], v[100:103], v[160:163]
    s_waitcnt vmcnt(3)
    v_mfma_f32_16x16x32_bf16 v[116:119], v[212:215], v[104:107], v[116:119]
    v_mfma_f32_16x16x32_bf16 v[120:123], v[212:215], v[108:111], v[120:123]
    v_mfma_f32_16x16x32_bf16 v[124:127], v[212:215], v[112:115], v[124:127]
    s_waitcnt vmcnt(2)
    v_mfma_f32_16x16x32_bf16 v[128:131], v[216:219], v[104:107], v[128:131]
    v_mfma_f32_16x16x32_bf16 v[132:135], v[216:219], v[108:111], v[132:135]
    v_mfma_f32_16x16x32_bf16 v[136:139], v[216:219], v[112:115], v[136:139]
    s_waitcnt vmcnt(1)
    v_mfma_f32_16x16x32_bf16 v[140:143], v[220:223], v[104:107], v[140:143]
    v_mfma_f32_16x16x32_bf16 v[144:147], v[220:223], v[108:111], v[144:147]
    v_mfma_f32_16x16x32_bf16 v[148:151], v[220:223], v[112:115], v[148:151]
    s_waitcnt vmcnt(0)
    v_mfma_f32_16x16x32_bf16 v[152:155], v[224:227], v[104:107], v[152:155]
    v_mfma_f32_16x16x32_bf16 v[156:159], v[224:227], v[108:111], v[156:159]
    v_mfma_f32_16x16x32_bf16 v[160:163], v[224:227], v[112:115], v[160:163]
    ds_write_b128 v7, v[116:119] offset:0
    ds_write_b128 v7, v[120:123] offset:2048
    ds_write_b128 v7, v[124:127] offset:4096
    ds_write_b128 v7, v[128:131] offset:1024
    ds_write_b128 v7, v[132:135] offset:3072
    ds_write_b128 v7, v[136:139] offset:5120
    ds_write_b128 v7, v[140:143] offset:6144
    ds_write_b128 v7, v[144:147] offset:8192
    ds_write_b128 v7, v[148:151] offset:10240
    ds_write_b128 v7, v[152:155] offset:7168
    ds_write_b128 v7, v[156:159] offset:9216
    ds_write_b128 v7, v[160:163] offset:11264
L_v_fin:
    s_sub_u32 s62, s36, 2
    s_lshl_b32 s60, s62, 11
    s_add_u32 s60, s60, 73728
    v_add_u32 v9, s60, v5
    s_mul_i32 s60, s49, 144
    s_mul_i32 s61, s50, 3
    s_add_u32 s60, s60, s61
    s_add_u32 s60, s60, s62
    s_cmp_ge_u32 s62, 3
    s_cselect_b32 s61, 69, 0
    s_add_u32 s60, s60, s61
    s_lshl_b32 s69, s60, 7
    s_add_u32 s69, s69, 9229312
    s_lshl_b32 s68, s60, 10
    s_add_u32 s68, s68, 7503872
    s_waitcnt lgkmcnt(0)
    s_barrier
    s_cmp_ge_u32 s62, 6
    s_cbranch_scc1 L_phase4b
    ds_read_b128 v[16:19], v9 offset:0
    ds_read_b128 v[20:23], v9 offset:1024
    ds_read_b128 v[24:27], v9 offset:12288
    ds_read_b128 v[28:31], v9 offset:13312
    ds_read_b128 v[32:35], v9 offset:24576
    ds_read_b128 v[36:39], v9 offset:25600
    ds_read_b128 v[40:43], v9 offset:36864
    ds_read_b128 v[44:47], v9 offset:37888
    s_waitcnt lgkmcnt(4)
    v_pk_add_f32 v[16:17], v[16:17], v[24:25]
    v_pk_add_f32 v[18:19], v[18:19], v[26:27]
    v_pk_add_f32 v[20:21], v[20:21], v[28:29]
    v_pk_add_f32 v[22:23], v[22:23], v[30:31]
    s_waitcnt lgkmcnt(2)
    v_pk_add_f32 v[16:17], v[16:17], v[32:33]
    v_pk_add_f32 v[18:19], v[18:19], v[34:35]
    v_pk_add_f32 v[20:21], v[20:21], v[36:37]
    v_pk_add_f32 v[22:23], v[22:23], v[38:39]
    s_waitcnt lgkmcnt(0)
    v_pk_add_f32 v[16:17], v[16:17], v[40:41]
    v_pk_add_f32 v[18:19], v[18:19], v[42:43]
    v_pk_add_f32 v[20:21], v[20:21], v[44:45]
    v_pk_add_f32 v[22:23], v[22:23], v[46:47]
    v_cvt_pk_bf16_f32 v48, v16, v17
    v_cvt_pk_bf16_f32 v49, v18, v19
    v_cvt_pk_bf16_f32 v50, v20, v21
    v_cvt_pk_bf16_f32 v51, v22, v23
    buffer_store_dwordx4 v[48:51], v5, s[32:35], s68 offen sc1
    s_waitcnt vmcnt(0)
    v_mov_b32 v254, 0
    v_mov_b32 v255, s40
    s_mov_b64 exec, 1
    buffer_store_dword v255, v254, s[32:35], s69 offen sc0 sc1
    s_mov_b64 exec, -1
    s_branch L_phase4b
L_aux_gemv_done:
    s_cmp_lg_u32 s95, 0
    s_cbranch_scc1 L_aux_s
L_aux:
    s_mov_b32 s56, 0x05040100
    s_mov_b32 s57, 0x07060302
    v_mul_u32_u24 v6, 9216, v4
    v_lshl_add_u32 v6, v3, 4, v6
    s_mul_i32 s60, s37, 73728
    v_add_u32 v6, s60, v6
    v_lshrrev_b32 v7, 1, v3
    v_mul_u32_u24 v7, 1040, v7
    v_and_b32 v8, 1, v3
    v_lshl_add_u32 v7, v8, 7, v7
    v_lshl_add_u32 v7, v4, 8, v7
    s_mul_i32 s60, s36, 8320
    v_add_u32 v7, s60, v7
    v_add_u32 v8, s60, v5
    s_lshr_b32 s60, s36, 2
    s_mul_i32 s60, s60, 40
    s_add_u32 s80, s97, s60
    v_mov_b32 v9, 0
    buffer_load_dword v10, v9, s[28:31], 0 offen sc0 sc1
    s_waitcnt vmcnt(0)
    s_mov_b32 s48, 0
nonce_40:
    v_readfirstlane_b32 s40, v10
    s_nop 1
    s_cmp_lg_u32 s40, 0
    s_cbranch_scc1 nonced_41
    buffer_load_dword v10, v9, s[28:31], 0 offen sc0 sc1
    s_waitcnt vmcnt(0)
    s_add_u32 s48, s48, 1
    s_cmp_lt_u32 s48, 2097152
    s_cbranch_scc1 nonce_40
nonced_41:
    s_and_b32 s98, s40, 0xff
    s_bfe_u32 s41, s40, 0x80008
    s_bfe_u32 s42, s40, 0x80010
    s_lshr_b32 s43, s40, 24
    s_cmp_lg_u32 s80, 39
    s_cbranch_scc1 L_trig0
    s_mov_b32 s80, 80
    s_branch L_pack_unit
L_trig0:
L_pack_unit:
    s_mul_i32 s81, s80, 7282
    s_lshr_b32 s81, s81, 16
    s_mul_i32 s82, s81, 9
    s_sub_u32 s82, s80, s82
    s_mul_i32 s60, s81, 294912
    s_lshl_b32 s61, s82, 8
    s_add_u32 s60, s60, s61
    buffer_load_dwordx4 v[12:15], v6, s[16:19], s60 offen nt
    s_add_u32 s60, s60, 2304
    buffer_load_dwordx4 v[16:19], v6, s[16:19], s60 offen nt
    s_add_u32 s60, s60, 2304
    buffer_load_dwordx4 v[20:23], v6, s[16:19], s60 offen nt
    s_add_u32 s60, s60, 2304
    buffer_load_dwordx4 v[24:27], v6, s[16:19], s60 offen nt
    s_add_u32 s60, s60, 29952
    buffer_load_dwordx4 v[28:31], v6, s[16:19], s60 offen nt
    s_add_u32 s60, s60, 2304
    buffer_load_dwordx4 v[32:35], v6, s[16:19], s60 offen nt
    s_add_u32 s60, s60, 2304
    buffer_load_dwordx4 v[36:39], v6, s[16:19], s60 offen nt
    s_add_u32 s60, s60, 2304
    buffer_load_dwordx4 v[40:43], v6, s[16:19], s60 offen nt
    s_lshl_b32 s64, s81, 2
    s_add_u32 s64, s64, s37
    s_lshl_b32 s65, s82, 3
    s_add_u32 s65, s65, 0
    s_mul_i32 s66, s65, 21846
    s_lshr_b32 s66, s66, 16
    s_mul_i32 s67, s66, 3
    s_sub_u32 s67, s65, s67
    s_mul_i32 s66, s66, 36
    s_add_u32 s66, s66, s64
    s_mul_i32 s66, s66, 3
    s_add_u32 s66, s66, s67
    s_lshl_b32 s66, s66, 10
    s_add_u32 s84, s66, 4849664
    s_lshl_b32 s65, s82, 3
    s_add_u32 s65, s65, 1
    s_mul_i32 s66, s65, 21846
    s_lshr_b32 s66, s66, 16
    s_mul_i32 s67, s66, 3
    s_sub_u32 s67, s65, s67
    s_mul_i32 s66, s66, 36
    s_add_u32 s66, s66, s64
    s_mul_i32 s66, s66, 3
    s_add_u32 s66, s66, s67
    s_lshl_b32 s66, s66, 10
    s_add_u32 s85, s66, 4849664
    s_lshl_b32 s65, s82, 3
    s_add_u32 s65, s65, 2
    s_mul_i32 s66, s65, 21846
    s_lshr_b32 s66, s66, 16
    s_mul_i32 s67, s66, 3
    s_sub_u32 s67, s65, s67
    s_mul_i32 s66, s66, 36
    s_add_u32 s66, s66, s64
    s_mul_i32 s66, s66, 3
    s_add_u32 s66, s66, s67
    s_lshl_b32 s66, s66, 10
    s_add_u32 s86, s66, 4849664
    s_lshl_b32 s65, s82, 3
    s_add_u32 s65, s65, 3
    s_mul_i32 s66, s65, 21846
    s_lshr_b32 s66, s66, 16
    s_mul_i32 s67, s66, 3
    s_sub_u32 s67, s65, s67
    s_mul_i32 s66, s66, 36
    s_add_u32 s66, s66, s64
    s_mul_i32 s66, s66, 3
    s_add_u32 s66, s66, s67
    s_lshl_b32 s66, s66, 10
    s_add_u32 s87, s66, 4849664
    s_lshl_b32 s65, s82, 3
    s_add_u32 s65, s65, 4
    s_mul_i32 s66, s65, 21846
    s_lshr_b32 s66, s66, 16
    s_mul_i32 s67, s66, 3
    s_sub_u32 s67, s65, s67
    s_mul_i32 s66, s66, 36
    s_add_u32 s66, s66, s64
    s_mul_i32 s66, s66, 3
    s_add_u32 s66, s66, s67
    s_lshl_b32 s66, s66, 10
    s_add_u32 s88, s66, 4849664
    s_lshl_b32 s65, s82, 3
    s_add_u32 s65, s65, 5
    s_mul_i32 s66, s65, 21846
    s_lshr_b32 s66, s66, 16
    s_mul_i32 s67, s66, 3
    s_sub_u32 s67, s65, s67
    s_mul_i32 s66, s66, 36
    s_add_u32 s66, s66, s64
    s_mul_i32 s66, s66, 3
    s_add_u32 s66, s66, s67
    s_lshl_b32 s66, s66, 10
    s_add_u32 s89, s66, 4849664
    s_lshl_b32 s65, s82, 3
    s_add_u32 s65, s65, 6
    s_mul_i32 s66, s65, 21846
    s_lshr_b32 s66, s66, 16
    s_mul_i32 s67, s66, 3
    s_sub_u32 s67, s65, s67
    s_mul_i32 s66, s66, 36
    s_add_u32 s66, s66, s64
    s_mul_i32 s66, s66, 3
    s_add_u32 s66, s66, s67
    s_lshl_b32 s66, s66, 10
    s_add_u32 s90, s66, 4849664
    s_lshl_b32 s65, s82, 3
    s_add_u32 s65, s65, 7
    s_mul_i32 s66, s65, 21846
    s_lshr_b32 s66, s66, 16
    s_mul_i32 s67, s66, 3
    s_sub_u32 s67, s65, s67
    s_mul_i32 s66, s66, 36
    s_add_u32 s66, s66, s64
    s_mul_i32 s66, s66, 3
    s_add_u32 s66, s66, s67
    s_lshl_b32 s66, s66, 10
    s_add_u32 s91, s66, 4849664
    s_mul_i32 s68, s64, 9
    s_add_u32 s68, s68, s82
    s_lshl_b32 s68, s68, 7
    s_add_u32 s68, s68, 9154560
    s_waitcnt vmcnt(0)
    v_perm_b32 v120, v16, v12, s56
    v_perm_b32 v121, v24, v20, s56
    v_perm_b32 v122, v32, v28, s56
    v_perm_b32 v123, v40, v36, s56
    ds_write_b128 v7, v[120:123] offset:0
    v_perm_b32 v124, v16, v12, s57
    v_perm_b32 v125, v24, v20, s57
    v_perm_b32 v126, v32, v28, s57
    v_perm_b32 v127, v40, v36, s57
    ds_write_b128 v7, v[124:127] offset:16
    v_perm_b32 v128, v17, v13, s56
    v_perm_b32 v129, v25, v21, s56
    v_perm_b32 v130, v33, v29, s56
    v_perm_b32 v131, v41, v37, s56
    ds_write_b128 v7, v[128:131] offset:32
    v_perm_b32 v132, v17, v13, s57
    v_perm_b32 v133, v25, v21, s57
    v_perm_b32 v134, v33, v29, s57
    v_perm_b32 v135, v41, v37, s57
    ds_write_b128 v7, v[132:135] offset:48
    v_perm_b32 v136, v18, v14, s56
    v_perm_b32 v137, v26, v22, s56
    v_perm_b32 v138, v34, v30, s56
    v_perm_b32 v139, v42, v38, s56
    ds_write_b128 v7, v[136:139] offset:64
    v_perm_b32 v140, v18, v14, s57
    v_perm_b32 v141, v26, v22, s57
    v_perm_b32 v142, v34, v30, s57
    v_perm_b32 v143, v42, v38, s57
    ds_write_b128 v7, v[140:143] offset:80
    v_perm_b32 v144, v19, v15, s56
    v_perm_b32 v145, v27, v23, s56
    v_perm_b32 v146, v35, v31, s56
    v_perm_b32 v147, v43, v39, s56
    ds_write_b128 v7, v[144:147] offset:96
    v_perm_b32 v148, v19, v15, s57
    v_perm_b32 v149, v27, v23, s57
    v_perm_b32 v150, v35, v31, s57
    v_perm_b32 v151, v43, v39, s57
    ds_write_b128 v7, v[148:151] offset:112
    ds_read_b128 v[160:163], v8 offset:0
    ds_read_b128 v[164:167], v8 offset:1040
    ds_read_b128 v[168:171], v8 offset:2080
    ds_read_b128 v[172:175], v8 offset:3120
    ds_read_b128 v[176:179], v8 offset:4160
    ds_read_b128 v[180:183], v8 offset:5200
    ds_read_b128 v[184:187], v8 offset:6240
    ds_read_b128 v[188:191], v8 offset:7280
    s_waitcnt lgkmcnt(7)
    buffer_store_dwordx4 v[160:163], v5, s[32:35], s84 offen sc1
    s_waitcnt lgkmcnt(6)
    buffer_store_dwordx4 v[164:167], v5, s[32:35], s85 offen sc1
    s_waitcnt lgkmcnt(5)
    buffer_store_dwordx4 v[168:171], v5, s[32:35], s86 offen sc1
    s_waitcnt lgkmcnt(4)
    buffer_store_dwordx4 v[172:175], v5, s[32:35], s87 offen sc1
    s_waitcnt lgkmcnt(3)
    buffer_store_dwordx4 v[176:179], v5, s[32:35], s88 offen sc1
    s_waitcnt lgkmcnt(2)
    buffer_store_dwordx4 v[180:183], v5, s[32:35], s89 offen sc1
    s_waitcnt lgkmcnt(1)
    buffer_store_dwordx4 v[184:187], v5, s[32:35], s90 offen sc1
    s_waitcnt lgkmcnt(0)
    buffer_store_dwordx4 v[188:191], v5, s[32:35], s91 offen sc1
    s_waitcnt vmcnt(0)
    v_mov_b32 v254, 0
    v_mov_b32 v255, s40
    s_mov_b64 exec, 1
    buffer_store_dword v255, v254, s[32:35], s68 offen sc0 sc1
    s_mov_b64 exec, -1
    s_cmp_lg_u32 s80, 80
    s_mov_b32 s80, 39
    s_cbranch_scc0 L_trig0
    s_cmp_ge_u32 s97, 36
    s_cbranch_scc1 L_aux_s
    s_lshr_b32 s60, s36, 2
    s_add_u32 s95, s60, 1
    s_lshl_b32 s96, s97, 1
    s_add_u32 s96, s96, s60
    s_add_u32 s96, s96, 144
    s_lshl_b32 s60, s60, 14
    s_add_u32 s94, s60, 98304
    s_branch L_gemv
L_aux_s:
    s_cmp_ge_u32 s36, 4
    s_cbranch_scc1 L_s_l
L_s_c:
    s_and_b32 s70, s38, 1
    s_lshl_b32 s70, s70, 2
    s_and_b32 s60, s39, 3
    s_add_u32 s70, s70, s60
    s_and_b32 s71, s38, 2
    s_bfe_u32 s60, s39, 0x10002
    s_add_u32 s71, s71, s60
    s_mul_i32 s61, s37, 5
    s_lshl_b32 s62, s51, 3
    s_add_u32 s63, s70, s62
    s_mul_i32 s63, s63, 18
    s_lshl_b32 s64, s71, 1
    s_add_u32 s64, s64, s62
    s_add_u32 s64, s64, 15
    s_mul_i32 s64, s64, 18
    v_and_b32 v252, 3, v2
    v_lshlrev_b32 v252, 1, v252
    v_min_u32 v252, 4, v252
    v_add_u32 v252, s61, v252
    v_lshrrev_b32 v252, 1, v252
    v_bfe_u32 v255, v2, 2, 2
    v_min_u32 v255, 2, v255
    v_mov_b32 v253, s63
    v_mad_u32_u24 v254, v255, 18, s64
    v_cmp_eq_u32 vcc, 0, v255
    s_nop 1
    v_cndmask_b32 v253, v254, v253, vcc
    v_add_u32 v252, v252, v253
    v_lshlrev_b32 v252, 7, v252
    s_mov_b32 s60, 8978432
    s_lshl_b32 s62, s51, 4
    s_lshl_b32 s72, s70, 1
    s_add_u32 s72, s72, s62
    s_mul_i32 s74, s72, 36
    s_add_u32 s74, s74, s61
    s_lshl_b32 s74, s74, 10
    s_add_u32 s74, s74, 1310720
    s_add_u32 s75, s74, 36864
    s_lshl_b32 s76, s71, 2
    s_add_u32 s76, s76, s62
    s_mul_i32 s76, s76, 36
    s_add_u32 s76, s76, s61
    s_lshl_b32 s76, s76, 10
    s_add_u32 s76, s76, 2490368
    s_add_u32 s77, s76, 36864
    s_add_u32 s78, s76, 73728
    s_add_u32 s79, s76, 110592
    s_bfe_u32 s73, s39, 0x10002
    s_lshl_b32 s73, s73, 1
    s_add_u32 s73, s73, s39
    s_and_b32 s73, s73, 3
    s_lshl_b32 s62, s36, 13
    v_add_u32 v8, s62, v5
    s_barrier
    s_mov_b32 s48, 0
    s_cmp_lt_u32 s39, s99
    s_cbranch_scc1 poll1d_45
    s_mov_b64 exec, 1
poll1_44:
    buffer_load_dword v253, v252, s[32:35], s60 offen sc0 sc1
    s_waitcnt vmcnt(0)
    v_cmp_ne_u32 vcc, s40, v253
    s_cbranch_vccz poll1d_45
    s_sleep 8
    s_add_u32 s48, s48, 1
    s_cmp_lt_u32 s48, 2097152
    s_cbranch_scc1 poll1_44
poll1d_45:
    s_mov_b64 exec, -1
poll_42:
    buffer_load_dword v253, v252, s[32:35], s60 offen sc0 sc1
    s_waitcnt vmcnt(0)
    v_cmp_ne_u32 vcc, s40, v253
    s_cbranch_vccz polld_43
    s_nop 0
    s_mov_b64 exec, vcc
    s_sleep 1
    s_add_u32 s48, s48, 1
    s_cmp_lt_u32 s48, 2097152
    s_cbranch_scc1 poll_42
polld_43:
    s_mov_b64 exec, -1
    v_lshl_add_u32 v6, s73, 10, v5
    buffer_load_dwordx4 v[16:19], v6, s[32:35], s74 offen sc1
    buffer_load_dwordx4 v[20:23], v6, s[32:35], s75 offen sc1
    buffer_load_dwordx4 v[24:27], v6, s[32:35], s76 offen sc1
    buffer_load_dwordx4 v[28:31], v6, s[32:35], s77 offen sc1
    buffer_load_dwordx4 v[32:35], v6, s[32:35], s78 offen sc1
    buffer_load_dwordx4 v[36:39], v6, s[32:35], s79 offen sc1
    s_add_u32 s73, s73, 1
    s_cmp_eq_u32 s73, 5
    s_cselect_b32 s73, 0, s73
    v_lshl_add_u32 v6, s73, 10, v5
    buffer_load_dwordx4 v[40:43], v6, s[32:35], s74 offen sc1
    buffer_load_dwordx4 v[44:47], v6, s[32:35], s75 offen sc1
    buffer_load_dwordx4 v[48:51], v6, s[32:35], s76 offen sc1
    buffer_load_dwordx4 v[52:55], v6, s[32:35], s77 offen sc1
    buffer_load_dwordx4 v[56:59], v6, s[32:35], s78 offen sc1
    buffer_load_dwordx4 v[60:63], v6, s[32:35], s79 offen sc1
    s_add_u32 s73, s73, 1
    s_cmp_eq_u32 s73, 5
    s_cselect_b32 s73, 0, s73
    v_lshl_add_u32 v6, s73, 10, v5
    buffer_load_dwordx4 v[64:67], v6, s[32:35], s74 offen sc1
    buffer_load_dwordx4 v[68:71], v6, s[32:35], s75 offen sc1
    buffer_load_dwordx4 v[72:75], v6, s[32:35], s76 offen sc1
    buffer_load_dwordx4 v[76:79], v6, s[32:35], s77 offen sc1
    buffer_load_dwordx4 v[80:83], v6, s[32:35], s78 offen sc1
    buffer_load_dwordx4 v[84:87], v6, s[32:35], s79 offen sc1
    s_add_u32 s73, s73, 1
    s_cmp_eq_u32 s73, 5
    s_cselect_b32 s73, 0, s73
    v_lshl_add_u32 v6, s73, 10, v5
    buffer_load_dwordx4 v[88:91], v6, s[32:35], s74 offen sc1
    buffer_load_dwordx4 v[92:95], v6, s[32:35], s75 offen sc1
    buffer_load_dwordx4 v[96:99], v6, s[32:35], s76 offen sc1
    buffer_load_dwordx4 v[100:103], v6, s[32:35], s77 offen sc1
    buffer_load_dwordx4 v[104:107], v6, s[32:35], s78 offen sc1
    buffer_load_dwordx4 v[108:111], v6, s[32:35], s79 offen sc1
    s_add_u32 s73, s73, 1
    s_cmp_eq_u32 s73, 5
    s_cselect_b32 s73, 0, s73
    v_lshl_add_u32 v6, s73, 10, v5
    buffer_load_dwordx4 v[112:115], v6, s[32:35], s74 offen sc1
    buffer_load_dwordx4 v[116:119], v6, s[32:35], s75 offen sc1
    buffer_load_dwordx4 v[120:123], v6, s[32:35], s76 offen sc1
    buffer_load_dwordx4 v[124:127], v6, s[32:35], s77 offen sc1
    buffer_load_dwordx4 v[128:131], v6, s[32:35], s78 offen sc1
    buffer_load_dwordx4 v[132:135], v6, s[32:35], s79 offen sc1
    s_waitcnt vmcnt(27)
    v_mfma_f32_16x16x32_bf16 v[140:143], v[24:27], v[16:19], 0
    v_mfma_f32_16x16x32_bf16 v[156:159], v[24:27], v[20:23], 0
    s_waitcnt vmcnt(26)
    v_mfma_f32_16x16x32_bf16 v[144:147], v[28:31], v[16:19], 0
    v_mfma_f32_16x16x32_bf16 v[160:163], v[28:31], v[20:23], 0
    s_waitcnt vmcnt(25)
    v_mfma_f32_16x16x32_bf16 v[148:151], v[32:35], v[16:19], 0
    v_mfma_f32_16x16x32_bf16 v[164:167], v[32:35], v[20:23], 0
    s_waitcnt vmcnt(24)
    v_mfma_f32_16x16x32_bf16 v[152:155], v[36:39], v[16:19], 0
    v_mfma_f32_16x16x32_bf16 v[168:171], v[36:39], v[20:23], 0
    s_waitcnt vmcnt(21)
    v_mfma_f32_16x16x32_bf16 v[140:143], v[48:51], v[40:43], v[140:143]
    v_mfma_f32_16x16x32_bf16 v[156:159], v[48:51], v[44:47], v[156:159]
    s_waitcnt vmcnt(20)
    v_mfma_f32_16x16x32_bf16 v[144:147], v[52:55], v[40:43], v[144:147]
    v_mfma_f32_16x16x32_bf16 v[160:163], v[52:55], v[44:47], v[160:163]
    s_waitcnt vmcnt(19)
    v_mfma_f32_16x16x32_bf16 v[148:151], v[56:59], v[40:43], v[148:151]
    v_mfma_f32_16x16x32_bf16 v[164:167], v[56:59], v[44:47], v[164:167]
    s_waitcnt vmcnt(18)
    v_mfma_f32_16x16x32_bf16 v[152:155], v[60:63], v[40:43], v[152:155]
    v_mfma_f32_16x16x32_bf16 v[168:171], v[60:63], v[44:47], v[168:171]
    s_waitcnt vmcnt(15)
    v_mfma_f32_16x16x32_bf16 v[140:143], v[72:75], v[64:67], v[140:143]
    v_mfma_f32_16x16x32_bf16 v[156:159], v[72:75], v[68:71], v[156:159]
    s_waitcnt vmcnt(14)
    v_mfma_f32_16x16x32_bf16 v[144:147], v[76:79], v[64:67], v[144:147]
    v_mfma_f32_16x16x32_bf16 v[160:163], v[76:79], v[68:71], v[160:163]
    s_waitcnt vmcnt(13)
    v_mfma_f32_16x16x32_bf16 v[148:151], v[80:83], v[64:67], v[148:151]
    v_mfma_f32_16x16x32_bf16 v[164:167], v[80:83], v[68:71], v[164:167]
    s_waitcnt vmcnt(12)
    v_mfma_f32_16x16x32_bf16 v[152:155], v[84:87], v[64:67], v[152:155]
    v_mfma_f32_16x16x32_bf16 v[168:171], v[84:87], v[68:71], v[168:171]
    s_waitcnt vmcnt(9)
    v_mfma_f32_16x16x32_bf16 v[140:143], v[96:99], v[88:91], v[140:143]
    v_mfma_f32_16x16x32_bf16 v[156:159], v[96:99], v[92:95], v[156:159]
    s_waitcnt vmcnt(8)
    v_mfma_f32_16x16x32_bf16 v[144:147], v[100:103], v[88:91], v[144:147]
    v_mfma_f32_16x16x32_bf16 v[160:163], v[100:103], v[92:95], v[160:163]
    s_waitcnt vmcnt(7)
    v_mfma_f32_16x16x32_bf16 v[148:151], v[104:107], v[88:91], v[148:151]
    v_mfma_f32_16x16x32_bf16 v[164:167], v[104:107], v[92:95], v[164:167]
    s_waitcnt vmcnt(6)
    v_mfma_f32_16x16x32_bf16 v[152:155], v[108:111], v[88:91], v[152:155]
    v_mfma_f32_16x16x32_bf16 v[168:171], v[108:111], v[92:95], v[168:171]
    s_waitcnt vmcnt(3)
    v_mfma_f32_16x16x32_bf16 v[140:143], v[120:123], v[112:115], v[140:143]
    v_mfma_f32_16x16x32_bf16 v[156:159], v[120:123], v[116:119], v[156:159]
    s_waitcnt vmcnt(2)
    v_mfma_f32_16x16x32_bf16 v[144:147], v[124:127], v[112:115], v[144:147]
    v_mfma_f32_16x16x32_bf16 v[160:163], v[124:127], v[116:119], v[160:163]
    s_waitcnt vmcnt(1)
    v_mfma_f32_16x16x32_bf16 v[148:151], v[128:131], v[112:115], v[148:151]
    v_mfma_f32_16x16x32_bf16 v[164:167], v[128:131], v[116:119], v[164:167]
    s_waitcnt vmcnt(0)
    v_mfma_f32_16x16x32_bf16 v[152:155], v[132:135], v[112:115], v[152:155]
    v_mfma_f32_16x16x32_bf16 v[168:171], v[132:135], v[116:119], v[168:171]
    ds_write_b128 v8, v[140:143] offset:0
    ds_write_b128 v8, v[144:147] offset:1024
    s_nop 1
    ds_write_b128 v8, v[148:151] offset:2048
    s_nop 1
    ds_write_b128 v8, v[152:155] offset:3072
    ds_write_b128 v8, v[156:159] offset:4096
    ds_write_b128 v8, v[160:163] offset:5120
    ds_write_b128 v8, v[164:167] offset:6144
    ds_write_b128 v8, v[168:171] offset:7168
    s_waitcnt lgkmcnt(0)
    s_barrier
    s_branch L_phase4
L_s_l:
    v_and_b32 v204, 1, v2
    v_lshlrev_b32 v204, 4, v204
    v_bfe_u32 v204, s40, v204, 16
    v_bfe_u32 v200, v204, 0, 2
    v_lshlrev_b32 v200, 14, v200
    v_lshrrev_b32 v205, 2, v204
    v_lshl_or_b32 v200, v205, 30, v200
    v_bfe_u32 v201, v204, 4, 2
    v_lshlrev_b32 v201, 14, v201
    v_lshrrev_b32 v205, 6, v204
    v_lshl_or_b32 v201, v205, 30, v201
    v_bfe_u32 v202, v204, 8, 2
    v_lshlrev_b32 v202, 14, v202
    v_lshrrev_b32 v205, 10, v204
    v_lshl_or_b32 v202, v205, 30, v202
    v_bfe_u32 v203, v204, 12, 2
    v_lshlrev_b32 v203, 14, v203
    v_lshrrev_b32 v205, 14, v204
    v_lshl_or_b32 v203, v205, 30, v203
    s_setprio 3
    s_and_b32 s70, s38, 1
    s_lshl_b32 s70, s70, 2
    s_and_b32 s60, s39, 3
    s_add_u32 s70, s70, s60
    s_and_b32 s71, s38, 2
    s_bfe_u32 s60, s39, 0x10002
    s_add_u32 s71, s71, s60
    s_mul_i32 s61, s37, 4
    s_add_u32 s61, s61, 20
    s_lshl_b32 s62, s51, 3
    s_add_u32 s63, s70, s62
    s_mul_i32 s63, s63, 18
    s_lshl_b32 s64, s71, 1
    s_add_u32 s64, s64, s62
    s_add_u32 s64, s64, 15
    s_mul_i32 s64, s64, 18
    v_and_b32 v252, 3, v2
    v_lshlrev_b32 v252, 1, v252
    v_min_u32 v252, 3, v252
    v_add_u32 v252, s61, v252
    v_lshrrev_b32 v252, 1, v252
    v_bfe_u32 v255, v2, 2, 2
    v_min_u32 v255, 2, v255
    v_mov_b32 v253, s63
    v_mad_u32_u24 v254, v255, 18, s64
    v_cmp_eq_u32 vcc, 0, v255
    s_nop 1
    v_cndmask_b32 v253, v254, v253, vcc
    v_add_u32 v252, v252, v253
    v_lshlrev_b32 v252, 7, v252
    s_mov_b32 s60, 8978432
    s_lshl_b32 s62, s51, 4
    s_lshl_b32 s72, s70, 1
    s_add_u32 s72, s72, s62
    s_mul_i32 s74, s72, 36
    s_add_u32 s74, s74, s61
    s_lshl_b32 s74, s74, 10
    s_add_u32 s74, s74, 1310720
    s_add_u32 s75, s74, 36864
    s_lshl_b32 s76, s71, 2
    s_add_u32 s76, s76, s62
    s_mul_i32 s76, s76, 36
    s_add_u32 s76, s76, s61
    s_lshl_b32 s76, s76, 10
    s_add_u32 s76, s76, 2490368
    s_add_u32 s77, s76, 36864
    s_add_u32 s78, s76, 73728
    s_add_u32 s79, s76, 110592
    s_bfe_u32 s73, s39, 0x10002
    s_lshl_b32 s73, s73, 1
    s_add_u32 s73, s73, s39
    s_and_b32 s73, s73, 3
    s_lshl_b32 s62, s36, 13
    v_add_u32 v8, s62, v5
    s_barrier
    s_mov_b32 s48, 0
    s_cmp_lt_u32 s39, s99
    s_cbranch_scc1 poll1d_49
    s_mov_b64 exec, 1
poll1_48:
    buffer_load_dword v253, v252, s[32:35], s60 offen sc0 sc1
    s_waitcnt vmcnt(0)
    v_cmp_ne_u32 vcc, s40, v253
    s_cbranch_vccz poll1d_49
    s_sleep 8
    s_add_u32 s48, s48, 1
    s_cmp_lt_u32 s48, 2097152
    s_cbranch_scc1 poll1_48
poll1d_49:
    s_mov_b64 exec, -1
poll_46:
    buffer_load_dword v253, v252, s[32:35], s60 offen sc0 sc1
    s_waitcnt vmcnt(0)
    v_cmp_ne_u32 vcc, s40, v253
    s_cbranch_vccz polld_47
    s_nop 0
    s_mov_b64 exec, vcc
    s_sleep 1
    s_add_u32 s48, s48, 1
    s_cmp_lt_u32 s48, 2097152
    s_cbranch_scc1 poll_46
polld_47:
    s_mov_b64 exec, -1
    v_lshl_add_u32 v6, s73, 10, v5
    buffer_load_dwordx4 v[16:19], v6, s[32:35], s74 offen sc1
    buffer_load_dwordx4 v[20:23], v6, s[32:35], s75 offen sc1
    buffer_load_dwordx4 v[24:27], v6, s[32:35], s76 offen sc1
    buffer_load_dwordx4 v[28:31], v6, s[32:35], s77 offen sc1
    buffer_load_dwordx4 v[32:35], v6, s[32:35], s78 offen sc1
    buffer_load_dwordx4 v[36:39], v6, s[32:35], s79 offen sc1
    s_add_u32 s73, s73, 1
    s_cmp_eq_u32 s73, 4
    s_cselect_b32 s73, 0, s73
    v_lshl_add_u32 v6, s73, 10, v5
    buffer_load_dwordx4 v[40:43], v6, s[32:35], s74 offen sc1
    buffer_load_dwordx4 v[44:47], v6, s[32:35], s75 offen sc1
    buffer_load_dwordx4 v[48:51], v6, s[32:35], s76 offen sc1
    buffer_load_dwordx4 v[52:55], v6, s[32:35], s77 offen sc1
    buffer_load_dwordx4 v[56:59], v6, s[32:35], s78 offen sc1
    buffer_load_dwordx4 v[60:63], v6, s[32:35], s79 offen sc1
    s_add_u32 s73, s73, 1
    s_cmp_eq_u32 s73, 4
    s_cselect_b32 s73, 0, s73
    v_lshl_add_u32 v6, s73, 10, v5
    buffer_load_dwordx4 v[64:67], v6, s[32:35], s74 offen sc1
    buffer_load_dwordx4 v[68:71], v6, s[32:35], s75 offen sc1
    buffer_load_dwordx4 v[72:75], v6, s[32:35], s76 offen sc1
    buffer_load_dwordx4 v[76:79], v6, s[32:35], s77 offen sc1
    buffer_load_dwordx4 v[80:83], v6, s[32:35], s78 offen sc1
    buffer_load_dwordx4 v[84:87], v6, s[32:35], s79 offen sc1
    s_add_u32 s73, s73, 1
    s_cmp_eq_u32 s73, 4
    s_cselect_b32 s73, 0, s73
    v_lshl_add_u32 v6, s73, 10, v5
    buffer_load_dwordx4 v[88:91], v6, s[32:35], s74 offen sc1
    buffer_load_dwordx4 v[92:95], v6, s[32:35], s75 offen sc1
    buffer_load_dwordx4 v[96:99], v6, s[32:35], s76 offen sc1
    buffer_load_dwordx4 v[100:103], v6, s[32:35], s77 offen sc1
    buffer_load_dwordx4 v[104:107], v6, s[32:35], s78 offen sc1
    buffer_load_dwordx4 v[108:111], v6, s[32:35], s79 offen sc1
    s_waitcnt vmcnt(21)
    v_mfma_f32_16x16x32_bf16 v[140:143], v[24:27], v[16:19], 0
    v_mfma_f32_16x16x32_bf16 v[156:159], v[24:27], v[20:23], 0
    s_waitcnt vmcnt(20)
    v_mfma_f32_16x16x32_bf16 v[144:147], v[28:31], v[16:19], 0
    v_mfma_f32_16x16x32_bf16 v[160:163], v[28:31], v[20:23], 0
    s_waitcnt vmcnt(19)
    v_mfma_f32_16x16x32_bf16 v[148:151], v[32:35], v[16:19], 0
    v_mfma_f32_16x16x32_bf16 v[164:167], v[32:35], v[20:23], 0
    s_waitcnt vmcnt(18)
    v_mfma_f32_16x16x32_bf16 v[152:155], v[36:39], v[16:19], 0
    v_mfma_f32_16x16x32_bf16 v[168:171], v[36:39], v[20:23], 0
    s_waitcnt vmcnt(15)
    v_mfma_f32_16x16x32_bf16 v[140:143], v[48:51], v[40:43], v[140:143]
    v_mfma_f32_16x16x32_bf16 v[156:159], v[48:51], v[44:47], v[156:159]
    s_waitcnt vmcnt(14)
    v_mfma_f32_16x16x32_bf16 v[144:147], v[52:55], v[40:43], v[144:147]
    v_mfma_f32_16x16x32_bf16 v[160:163], v[52:55], v[44:47], v[160:163]
    s_waitcnt vmcnt(13)
    v_mfma_f32_16x16x32_bf16 v[148:151], v[56:59], v[40:43], v[148:151]
    v_mfma_f32_16x16x32_bf16 v[164:167], v[56:59], v[44:47], v[164:167]
    s_waitcnt vmcnt(12)
    v_mfma_f32_16x16x32_bf16 v[152:155], v[60:63], v[40:43], v[152:155]
    v_mfma_f32_16x16x32_bf16 v[168:171], v[60:63], v[44:47], v[168:171]
    s_waitcnt vmcnt(9)
    v_mfma_f32_16x16x32_bf16 v[140:143], v[72:75], v[64:67], v[140:143]
    v_mfma_f32_16x16x32_bf16 v[156:159], v[72:75], v[68:71], v[156:159]
    s_waitcnt vmcnt(8)
    v_mfma_f32_16x16x32_bf16 v[144:147], v[76:79], v[64:67], v[144:147]
    v_mfma_f32_16x16x32_bf16 v[160:163], v[76:79], v[68:71], v[160:163]
    s_waitcnt vmcnt(7)
    v_mfma_f32_16x16x32_bf16 v[148:151], v[80:83], v[64:67], v[148:151]
    v_mfma_f32_16x16x32_bf16 v[164:167], v[80:83], v[68:71], v[164:167]
    s_waitcnt vmcnt(6)
    v_mfma_f32_16x16x32_bf16 v[152:155], v[84:87], v[64:67], v[152:155]
    v_mfma_f32_16x16x32_bf16 v[168:171], v[84:87], v[68:71], v[168:171]
    s_waitcnt vmcnt(3)
    v_mfma_f32_16x16x32_bf16 v[140:143], v[96:99], v[88:91], v[140:143]
    v_mfma_f32_16x16x32_bf16 v[156:159], v[96:99], v[92:95], v[156:159]
    s_waitcnt vmcnt(2)
    v_mfma_f32_16x16x32_bf16 v[144:147], v[100:103], v[88:91], v[144:147]
    v_mfma_f32_16x16x32_bf16 v[160:163], v[100:103], v[92:95], v[160:163]
    s_waitcnt vmcnt(1)
    v_mfma_f32_16x16x32_bf16 v[148:151], v[104:107], v[88:91], v[148:151]
    v_mfma_f32_16x16x32_bf16 v[164:167], v[104:107], v[92:95], v[164:167]
    s_waitcnt vmcnt(0)
    v_mfma_f32_16x16x32_bf16 v[152:155], v[108:111], v[88:91], v[152:155]
    v_mfma_f32_16x16x32_bf16 v[168:171], v[108:111], v[92:95], v[168:171]
    ds_write_b128 v8, v[140:143] offset:0
    ds_write_b128 v8, v[144:147] offset:1024
    s_nop 1
    ds_write_b128 v8, v[148:151] offset:2048
    s_nop 1
    ds_write_b128 v8, v[152:155] offset:3072
    ds_write_b128 v8, v[156:159] offset:4096
    ds_write_b128 v8, v[160:163] offset:5120
    ds_write_b128 v8, v[164:167] offset:6144
    ds_write_b128 v8, v[168:171] offset:7168
    s_waitcnt lgkmcnt(0)
    s_barrier
    s_lshl_b32 s60, s37, 11
    v_add_u32 v9, s60, v5
    ds_read_b128 v[16:19], v9 offset:0
    ds_read_b128 v[20:23], v9 offset:1024
    ds_read_b128 v[24:27], v9 offset:8192
    ds_read_b128 v[28:31], v9 offset:9216
    ds_read_b128 v[32:35], v9 offset:16384
    ds_read_b128 v[36:39], v9 offset:17408
    ds_read_b128 v[40:43], v9 offset:24576
    ds_read_b128 v[44:47], v9 offset:25600
    ds_read_b128 v[48:51], v9 offset:32768
    ds_read_b128 v[52:55], v9 offset:33792
    ds_read_b128 v[56:59], v9 offset:40960
    ds_read_b128 v[60:63], v9 offset:41984
    ds_read_b128 v[64:67], v9 offset:49152
    ds_read_b128 v[68:71], v9 offset:50176
    ds_read_b128 v[72:75], v9 offset:57344
    ds_read_b128 v[76:79], v9 offset:58368
    s_lshr_b32 s60, s37, 1
    s_add_u32 s72, s72, s60
    s_lshl_b32 s72, s72, 2
    s_add_u32 s72, s72, s71
    s_lshl_b32 s72, s72, 1
    s_and_b32 s60, s37, 1
    s_add_u32 s72, s72, s60
    s_lshl_b32 s63, s72, 10
    s_add_u32 s63, s63, 8683520
    s_lshl_b32 s64, s72, 7
    s_add_u32 s64, s64, 8945664
    s_lshl_b32 s65, s72, 7
    s_add_u32 s65, s65, 9196544
    s_mov_b32 s66, 0x3d2e1a93
    s_waitcnt lgkmcnt(12)
    v_pk_add_f32 v[16:17], v[16:17], v[24:25]
    v_pk_add_f32 v[18:19], v[18:19], v[26:27]
    v_pk_add_f32 v[20:21], v[20:21], v[28:29]
    v_pk_add_f32 v[22:23], v[22:23], v[30:31]
    s_waitcnt lgkmcnt(8)
    v_pk_add_f32 v[32:33], v[32:33], v[40:41]
    v_pk_add_f32 v[34:35], v[34:35], v[42:43]
    v_pk_add_f32 v[36:37], v[36:37], v[44:45]
    v_pk_add_f32 v[38:39], v[38:39], v[46:47]
    v_pk_add_f32 v[16:17], v[16:17], v[32:33]
    v_pk_add_f32 v[18:19], v[18:19], v[34:35]
    v_pk_add_f32 v[20:21], v[20:21], v[36:37]
    v_pk_add_f32 v[22:23], v[22:23], v[38:39]
    s_waitcnt lgkmcnt(4)
    v_pk_add_f32 v[48:49], v[48:49], v[56:57]
    v_pk_add_f32 v[50:51], v[50:51], v[58:59]
    v_pk_add_f32 v[52:53], v[52:53], v[60:61]
    v_pk_add_f32 v[54:55], v[54:55], v[62:63]
    v_pk_add_f32 v[16:17], v[16:17], v[48:49]
    v_pk_add_f32 v[18:19], v[18:19], v[50:51]
    v_pk_add_f32 v[20:21], v[20:21], v[52:53]
    v_pk_add_f32 v[22:23], v[22:23], v[54:55]
    s_waitcnt lgkmcnt(0)
    v_pk_add_f32 v[64:65], v[64:65], v[72:73]
    v_pk_add_f32 v[66:67], v[66:67], v[74:75]
    v_pk_add_f32 v[68:69], v[68:69], v[76:77]
    v_pk_add_f32 v[70:71], v[70:71], v[78:79]
    v_pk_add_f32 v[16:17], v[16:17], v[64:65]
    v_pk_add_f32 v[18:19], v[18:19], v[66:67]
    v_pk_add_f32 v[20:21], v[20:21], v[68:69]
    v_pk_add_f32 v[22:23], v[22:23], v[70:71]
    v_maximum3_f32 v30, v16, v17, v18
    v_maximum3_f32 v31, v19, v20, v21
    v_maximum3_f32 v30, v30, v22, v23
    v_maximum3_f32 v30, v30, v31, v31
    v_mov_b32 v31, v30
    s_nop 1
    v_permlane16_swap_b32 v30, v31
    v_maximum3_f32 v30, v30, v31, v31
    v_mov_b32 v31, v30
    s_nop 1
    v_permlane32_swap_b32 v30, v31
    v_maximum3_f32 v30, v30, v31, v31
    v_mul_f32 v30, s66, v30
    v_fma_f32 v16, v16, s66, -v30
    v_fma_f32 v17, v17, s66, -v30
    v_fma_f32 v18, v18, s66, -v30
    v_fma_f32 v19, v19, s66, -v30
    v_fma_f32 v20, v20, s66, -v30
    v_fma_f32 v21, v21, s66, -v30
    v_fma_f32 v22, v22, s66, -v30
    v_fma_f32 v23, v23, s66, -v30
    v_lshlrev_b32 v10, 3, v2
    v_mov_b32 v31, s40
    v_exp_f32_e64 v16, v16 clamp
    v_exp_f32_e64 v17, v17 clamp
    v_exp_f32_e64 v18, v18 clamp
    v_exp_f32_e64 v19, v19 clamp
    v_exp_f32_e64 v20, v20 clamp
    v_exp_f32_e64 v21, v21 clamp
    v_exp_f32_e64 v22, v22 clamp
    v_exp_f32_e64 v23, v23 clamp
    v_cvt_pk_bf16_f32 v32, v16, v17
    v_cvt_pk_bf16_f32 v33, v18, v19
    v_cvt_pk_bf16_f32 v34, v20, v21
    v_cvt_pk_bf16_f32 v35, v22, v23
    v_or_b32 v32, v32, v200
    v_or_b32 v33, v33, v201
    v_or_b32 v34, v34, v202
    v_or_b32 v35, v35, v203
    buffer_store_dwordx4 v[32:35], v5, s[32:35], s63 offen sc1
    s_mov_b64 exec, 0xffff
    buffer_store_dwordx2 v[30:31], v10, s[32:35], s64 offen sc1
    s_mov_b64 exec, -1
    s_barrier
    s_branch L_fin
L_phase4:
    s_cmp_lt_u32 s36, 3
    s_cbranch_scc1 L_phase4a
    s_barrier
    v_min_u32 v253, 35, v2
    v_lshlrev_b32 v253, 4, v253
    s_mul_i32 s88, s51, 55296
    s_mul_i32 s89, s53, 576
    s_add_u32 s88, s88, s89
    s_add_u32 s88, s88, 1188864
    s_add_u32 s89, s88, 13824
    s_add_u32 s90, s88, 27648
    s_add_u32 s91, s88, 41472
    s_mov_b32 s48, 0
gate_50:
    buffer_load_dwordx4 v[100:103], v253, s[32:35], s88 offen sc0 sc1
    buffer_load_dwordx4 v[104:107], v253, s[32:35], s89 offen sc0 sc1
    buffer_load_dwordx4 v[108:111], v253, s[32:35], s90 offen sc0 sc1
    buffer_load_dwordx4 v[112:115], v253, s[32:35], s91 offen sc0 sc1
    s_waitcnt vmcnt(0)
    v_xor_b32 v100, s98, v100
    v_xor_b32 v101, s41, v101
    v_xor_b32 v102, s42, v102
    v_xor_b32 v103, s43, v103
    v_xor_b32 v104, s98, v104
    v_xor_b32 v105, s41, v105
    v_xor_b32 v106, s42, v106
    v_xor_b32 v107, s43, v107
    v_xor_b32 v108, s98, v108
    v_xor_b32 v109, s41, v109
    v_xor_b32 v110, s42, v110
    v_xor_b32 v111, s43, v111
    v_xor_b32 v112, s98, v112
    v_xor_b32 v113, s41, v113
    v_xor_b32 v114, s42, v114
    v_xor_b32 v115, s43, v115
    v_or_b32 v255, v100, v101
    v_or3_b32 v255, v102, v103, v255
    v_or3_b32 v255, v104, v105, v255
    v_or3_b32 v255, v106, v107, v255
    v_or3_b32 v255, v108, v109, v255
    v_or3_b32 v255, v110, v111, v255
    v_or3_b32 v255, v112, v113, v255
    v_or3_b32 v255, v114, v115, v255
    v_and_b32 v255, 0xff, v255
    v_cmp_ne_u32 vcc, 0, v255
    s_cbranch_vccz gate_ok_51
    s_sleep 4
    s_add_u32 s48, s48, 1
    s_cmp_lt_u32 s48, 2097152
    s_cbranch_scc1 gate_50
gate_ok_51:
    v_add_f32 v100, v100, v104
    v_add_f32 v108, v108, v112
    v_add_f32 v101, v101, v105
    v_add_f32 v109, v109, v113
    v_add_f32 v102, v102, v106
    v_add_f32 v110, v110, v114
    v_add_f32 v103, v103, v107
    v_add_f32 v111, v111, v115
    v_add_f32 v100, v100, v108
    v_cvt_pk_bf16_f32 v100, v100, v100
    v_lshlrev_b32 v100, 16, v100
    v_add_f32 v101, v101, v109
    v_cvt_pk_bf16_f32 v101, v101, v101
    v_lshlrev_b32 v101, 16, v101
    v_add_f32 v102, v102, v110
    v_cvt_pk_bf16_f32 v102, v102, v102
    v_lshlrev_b32 v102, 16, v102
    v_add_f32 v103, v103, v111
    v_cvt_pk_bf16_f32 v103, v103, v103
    v_lshlrev_b32 v103, 16, v103
    v_add_u32 v253, 160832, v253
    ds_write_b128 v253, v[100:103]
    s_waitcnt lgkmcnt(0)
    s_mov_b64 exec, 1
    v_mov_b32 v253, 160768
    v_mov_b32 v254, 1
    ds_add_u32 v253, v254 offset:48
    s_mov_b64 exec, -1
    s_branch L_fin
L_phase4a:
    v_mul_u32_u24 v250, 2304, v3
    v_lshl_add_u32 v250, v4, 3, v250
    s_mul_i32 s89, s53, 3
    s_add_u32 s89, s89, s36
    s_mul_i32 s54, s52, 36864
    s_mul_i32 s90, s89, 96
    s_add_u32 s54, s54, s90
    buffer_load_dwordx2 v[244:245], v250, s[4:7], s54 offen offset:0
    buffer_load_dwordx2 v[246:247], v250, s[4:7], s54 offen offset:32
    buffer_load_dwordx2 v[248:249], v250, s[4:7], s54 offen offset:64
    s_lshl_b32 s63, s51, 6
    s_add_u32 s63, s63, s53
    s_mul_i32 s63, s63, 9
    s_mul_i32 s61, s36, 3
    s_add_u32 s63, s63, s61
    s_lshl_b32 s61, s63, 7
    s_add_u32 s61, s61, 9229312
    v_and_b32 v6, 7, v2
    v_bfe_u32 v7, v2, 3, 2
    v_min_u32 v7, 2, v7
    v_mul_u32_u24 v9, 72, v6
    v_add_u32 v9, v9, v7
    v_lshl_add_u32 v252, v9, 7, s61
    s_lshl_b32 s64, s52, 13
    s_add_u32 s64, s64, 8683520
    s_lshl_b32 s65, s52, 10
    s_add_u32 s65, s65, 8945664
    v_and_b32 v228, 1, v2
    v_lshlrev_b32 v228, 4, v228
    v_bfe_u32 v228, s40, v228, 16
    v_bfe_u32 v224, v228, 0, 2
    v_lshlrev_b32 v224, 14, v224
    v_lshrrev_b32 v229, 2, v228
    v_lshl_or_b32 v224, v229, 30, v224
    v_bfe_u32 v225, v228, 4, 2
    v_lshlrev_b32 v225, 14, v225
    v_lshrrev_b32 v229, 6, v228
    v_lshl_or_b32 v225, v229, 30, v225
    v_bfe_u32 v226, v228, 8, 2
    v_lshlrev_b32 v226, 14, v226
    v_lshrrev_b32 v229, 10, v228
    v_lshl_or_b32 v226, v229, 30, v226
    v_bfe_u32 v227, v228, 12, 2
    v_lshlrev_b32 v227, 14, v227
    v_lshrrev_b32 v229, 14, v228
    v_lshl_or_b32 v227, v229, 30, v227
    s_lshl_b32 s63, s63, 10
    s_add_u32 s63, s63, 7503872
    v_mov_b32 v12, 0x3f803f80
    v_mov_b32 v13, 0x3f803f80
    v_mov_b32 v14, 0x3f803f80
    v_mov_b32 v15, 0x3f803f80
    s_mul_i32 s71, s39, 3
    s_add_u32 s60, s71, 0
    s_and_b32 s60, s60, 7
    s_lshl_b32 s72, s60, 7
    s_add_u32 s72, s72, s65
    s_mul_i32 s8, s60, 73728
    s_add_u32 s8, s8, s63
    s_lshl_b32 s80, s60, 10
    s_add_u32 s80, s80, s64
    s_add_u32 s60, s71, 1
    s_and_b32 s60, s60, 7
    s_lshl_b32 s73, s60, 7
    s_add_u32 s73, s73, s65
    s_mul_i32 s9, s60, 73728
    s_add_u32 s9, s9, s63
    s_lshl_b32 s81, s60, 10
    s_add_u32 s81, s81, s64
    s_add_u32 s60, s71, 2
    s_and_b32 s60, s60, 7
    s_lshl_b32 s74, s60, 7
    s_add_u32 s74, s74, s65
    s_mul_i32 s10, s60, 73728
    s_add_u32 s10, s10, s63
    s_lshl_b32 s82, s60, 10
    s_add_u32 s82, s82, s64
    s_add_u32 s60, s71, 3
    s_and_b32 s60, s60, 7
    s_lshl_b32 s75, s60, 7
    s_add_u32 s75, s75, s65
    s_mul_i32 s11, s60, 73728
    s_add_u32 s11, s11, s63
    s_lshl_b32 s83, s60, 10
    s_add_u32 s83, s83, s64
    s_add_u32 s60, s71, 4
    s_and_b32 s60, s60, 7
    s_lshl_b32 s76, s60, 7
    s_add_u32 s76, s76, s65
    s_mul_i32 s12, s60, 73728
    s_add_u32 s12, s12, s63
    s_lshl_b32 s84, s60, 10
    s_add_u32 s84, s84, s64
    s_add_u32 s60, s71, 5
    s_and_b32 s60, s60, 7
    s_lshl_b32 s77, s60, 7
    s_add_u32 s77, s77, s65
    s_mul_i32 s13, s60, 73728
    s_add_u32 s13, s13, s63
    s_lshl_b32 s85, s60, 10
    s_add_u32 s85, s85, s64
    s_add_u32 s60, s71, 6
    s_and_b32 s60, s60, 7
    s_lshl_b32 s78, s60, 7
    s_add_u32 s78, s78, s65
    s_mul_i32 s14, s60, 73728
    s_add_u32 s14, s14, s63
    s_lshl_b32 s86, s60, 10
    s_add_u32 s86, s86, s64
    s_add_u32 s60, s71, 7
    s_and_b32 s60, s60, 7
    s_lshl_b32 s79, s60, 7
    s_add_u32 s79, s79, s65
    s_mul_i32 s15, s60, 73728
    s_add_u32 s15, s15, s63
    s_lshl_b32 s87, s60, 10
    s_add_u32 s87, s87, s64
    s_barrier
    s_branch L_phase4c
L_phase4b:
    s_barrier
    s_cmp_ge_u32 s36, 3
    s_cbranch_scc1 L_fin
L_phase4c:
    v_and_b32 v251, 7, v2
    s_lshl_b32 s60, s52, 10
    s_add_u32 s60, s60, 8945668
    v_lshl_add_u32 v251, v251, 7, s60
    v_lshlrev_b32 v10, 3, v3
    v_mul_u32_u24 v250, 2304, v3
    v_lshl_add_u32 v250, v4, 3, v250
    s_mov_b32 s61, 0xc000c000
    s_waitcnt vmcnt(0)
    v_lshlrev_b32 v212, 16, v244
    v_and_b32 v213, s47, v244
    v_lshlrev_b32 v214, 16, v245
    v_and_b32 v215, s47, v245
    v_lshlrev_b32 v216, 16, v246
    v_and_b32 v217, s47, v246
    v_lshlrev_b32 v218, 16, v247
    v_and_b32 v219, s47, v247
    v_lshlrev_b32 v220, 16, v248
    v_and_b32 v221, s47, v248
    v_lshlrev_b32 v222, 16, v249
    v_and_b32 v223, s47, v249
    s_mul_i32 s60, s36, 192
    s_add_u32 s60, s60, 160832
    v_lshl_add_u32 v229, v4, 4, s60
    s_mov_b32 s48, 0
    s_cmp_ge_u32 s39, 24
    s_cbranch_scc1 poll1d_55
    s_mov_b64 exec, 1
poll1_54:
    buffer_load_dword v253, v252, s[32:35], 0 offen sc0 sc1
    s_waitcnt vmcnt(0)
    v_cmp_ne_u32 vcc, s40, v253
    s_cbranch_vccz poll1d_55
    s_sleep 8
    s_add_u32 s48, s48, 1
    s_cmp_lt_u32 s48, 2097152
    s_cbranch_scc1 poll1_54
poll1d_55:
    s_mov_b64 exec, -1
poll_52:
    buffer_load_dword v253, v252, s[32:35], 0 offen sc0 sc1
    s_waitcnt vmcnt(0)
    v_cmp_ne_u32 vcc, s40, v253
    s_cbranch_vccz polld_53
    s_nop 0
    s_mov_b64 exec, vcc
    s_sleep 1
    s_add_u32 s48, s48, 1
    s_cmp_lt_u32 s48, 2097152
    s_cbranch_scc1 poll_52
polld_53:
    s_mov_b64 exec, -1
    buffer_load_dwordx2 v[152:153], v10, s[32:35], s72 offen sc1
    buffer_load_dwordx2 v[154:155], v10, s[32:35], s73 offen sc1
    buffer_load_dwordx2 v[156:157], v10, s[32:35], s74 offen sc1
    buffer_load_dwordx2 v[158:159], v10, s[32:35], s75 offen sc1
    buffer_load_dwordx2 v[160:161], v10, s[32:35], s76 offen sc1
    buffer_load_dwordx2 v[162:163], v10, s[32:35], s77 offen sc1
    buffer_load_dwordx2 v[164:165], v10, s[32:35], s78 offen sc1
    buffer_load_dwordx2 v[166:167], v10, s[32:35], s79 offen sc1
    buffer_load_dwordx4 v[24:27], v5, s[32:35], s80 offen sc1
    buffer_load_dwordx4 v[28:31], v5, s[32:35], s81 offen sc1
    buffer_load_dwordx4 v[32:35], v5, s[32:35], s82 offen sc1
    buffer_load_dwordx4 v[36:39], v5, s[32:35], s83 offen sc1
    buffer_load_dwordx4 v[40:43], v5, s[32:35], s84 offen sc1
    buffer_load_dwordx4 v[44:47], v5, s[32:35], s85 offen sc1
    buffer_load_dwordx4 v[48:51], v5, s[32:35], s86 offen sc1
    buffer_load_dwordx4 v[52:55], v5, s[32:35], s87 offen sc1
    buffer_load_dwordx4 v[56:59], v5, s[32:35], s8 offen offset:0 sc1
    buffer_load_dwordx4 v[60:63], v5, s[32:35], s8 offen offset:1024 sc1
    buffer_load_dwordx4 v[64:67], v5, s[32:35], s8 offen offset:2048 sc1
    buffer_load_dwordx4 v[68:71], v5, s[32:35], s9 offen offset:0 sc1
    buffer_load_dwordx4 v[72:75], v5, s[32:35], s9 offen offset:1024 sc1
    buffer_load_dwordx4 v[76:79], v5, s[32:35], s9 offen offset:2048 sc1
    buffer_load_dwordx4 v[80:83], v5, s[32:35], s10 offen offset:0 sc1
    buffer_load_dwordx4 v[84:87], v5, s[32:35], s10 offen offset:1024 sc1
    buffer_load_dwordx4 v[88:91], v5, s[32:35], s10 offen offset:2048 sc1
    buffer_load_dwordx4 v[92:95], v5, s[32:35], s11 offen offset:0 sc1
    buffer_load_dwordx4 v[96:99], v5, s[32:35], s11 offen offset:1024 sc1
    buffer_load_dwordx4 v[100:103], v5, s[32:35], s11 offen offset:2048 sc1
    s_mov_b32 s62, 0
    s_waitcnt vmcnt(12)
    v_xor_b32 v153, s40, v153
    v_xor_b32 v155, s40, v155
    v_xor_b32 v157, s40, v157
    v_xor_b32 v159, s40, v159
    v_xor_b32 v161, s40, v161
    v_xor_b32 v163, s40, v163
    v_xor_b32 v165, s40, v165
    buffer_load_dwordx4 v[104:107], v5, s[32:35], s12 offen offset:0 sc1
    v_xor_b32 v167, s40, v167
    v_maximum3_f32 v7, v152, v154, v156
    v_maximum3_f32 v8, v158, v160, v162
    v_or3_b32 v9, v153, v155, v157
    v_maximum3_f32 v7, v7, v164, v166
    v_or3_b32 v9, v9, v159, v161
    v_maximum3_f32 v7, v7, v8, v8
    buffer_load_dwordx4 v[108:111], v5, s[32:35], s12 offen offset:1024 sc1
    v_or3_b32 v9, v9, v163, v165
    v_or_b32 v9, v9, v167
    v_sub_f32 v16, v152, v7
    v_sub_f32 v17, v154, v7
    v_sub_f32 v18, v156, v7
    v_sub_f32 v19, v158, v7
    v_sub_f32 v20, v160, v7
    buffer_load_dwordx4 v[112:115], v5, s[32:35], s12 offen offset:2048 sc1
    v_sub_f32 v21, v162, v7
    v_sub_f32 v22, v164, v7
    v_sub_f32 v23, v166, v7
    v_exp_f32 v16, v16
    v_exp_f32 v17, v17
    v_exp_f32 v18, v18
    v_exp_f32 v19, v19
    buffer_load_dwordx4 v[116:119], v5, s[32:35], s13 offen offset:0 sc1
    v_exp_f32 v20, v20
    v_exp_f32 v21, v21
    v_exp_f32 v22, v22
    v_exp_f32 v23, v23
    v_mov_b32 v8, 0
    v_xor_b32 v24, v24, v224
    v_xor_b32 v25, v25, v225
    buffer_load_dwordx4 v[120:123], v5, s[32:35], s13 offen offset:1024 sc1
    v_xor_b32 v26, v26, v226
    v_xor_b32 v27, v27, v227
    v_or3_b32 v8, v8, v24, v25
    v_or3_b32 v8, v8, v26, v27
    v_mfma_f32_16x16x32_bf16 v[168:171], v[12:15], v[24:27], 0
    v_xor_b32 v28, v28, v224
    v_xor_b32 v29, v29, v225
    buffer_load_dwordx4 v[124:127], v5, s[32:35], s13 offen offset:2048 sc1
    v_xor_b32 v30, v30, v226
    v_xor_b32 v31, v31, v227
    v_or3_b32 v8, v8, v28, v29
    v_or3_b32 v8, v8, v30, v31
    v_mfma_f32_16x16x32_bf16 v[172:175], v[12:15], v[28:31], 0
    v_xor_b32 v32, v32, v224
    v_xor_b32 v33, v33, v225
    buffer_load_dwordx4 v[128:131], v5, s[32:35], s14 offen offset:0 sc1
    v_xor_b32 v34, v34, v226
    v_xor_b32 v35, v35, v227
    v_or3_b32 v8, v8, v32, v33
    v_or3_b32 v8, v8, v34, v35
    v_mfma_f32_16x16x32_bf16 v[176:179], v[12:15], v[32:35], 0
    v_xor_b32 v36, v36, v224
    v_xor_b32 v37, v37, v225
    buffer_load_dwordx4 v[132:135], v5, s[32:35], s14 offen offset:1024 sc1
    v_xor_b32 v38, v38, v226
    v_xor_b32 v39, v39, v227
    v_or3_b32 v8, v8, v36, v37
    v_or3_b32 v8, v8, v38, v39
    v_mfma_f32_16x16x32_bf16 v[180:183], v[12:15], v[36:39], 0
    v_xor_b32 v40, v40, v224
    v_xor_b32 v41, v41, v225
    buffer_load_dwordx4 v[136:139], v5, s[32:35], s14 offen offset:2048 sc1
    v_xor_b32 v42, v42, v226
    v_xor_b32 v43, v43, v227
    v_or3_b32 v8, v8, v40, v41
    v_or3_b32 v8, v8, v42, v43
    v_mfma_f32_16x16x32_bf16 v[184:187], v[12:15], v[40:43], 0
    v_xor_b32 v44, v44, v224
    v_xor_b32 v45, v45, v225
    buffer_load_dwordx4 v[140:143], v5, s[32:35], s15 offen offset:0 sc1
    v_xor_b32 v46, v46, v226
    v_xor_b32 v47, v47, v227
    v_or3_b32 v8, v8, v44, v45
    v_or3_b32 v8, v8, v46, v47
    v_mfma_f32_16x16x32_bf16 v[188:191], v[12:15], v[44:47], 0
    v_xor_b32 v48, v48, v224
    v_xor_b32 v49, v49, v225
    buffer_load_dwordx4 v[144:147], v5, s[32:35], s15 offen offset:1024 sc1
    v_xor_b32 v50, v50, v226
    v_xor_b32 v51, v51, v227
    v_or3_b32 v8, v8, v48, v49
    v_or3_b32 v8, v8, v50, v51
    v_mfma_f32_16x16x32_bf16 v[192:195], v[12:15], v[48:51], 0
    v_xor_b32 v52, v52, v224
    v_xor_b32 v53, v53, v225
    buffer_load_dwordx4 v[148:151], v5, s[32:35], s15 offen offset:2048 sc1
    v_xor_b32 v54, v54, v226
    v_xor_b32 v55, v55, v227
    v_or3_b32 v8, v8, v52, v53
    v_or3_b32 v8, v8, v54, v55
    v_mfma_f32_16x16x32_bf16 v[196:199], v[12:15], v[52:55], 0
    v_and_or_b32 v9, v8, s61, v9
    v_cmp_ne_u32 vcc, 0, v9
    s_cbranch_vccz L_pok
L_pload:
    buffer_load_dwordx2 v[152:153], v10, s[32:35], s72 offen sc1
    buffer_load_dwordx2 v[154:155], v10, s[32:35], s73 offen sc1
    buffer_load_dwordx2 v[156:157], v10, s[32:35], s74 offen sc1
    buffer_load_dwordx2 v[158:159], v10, s[32:35], s75 offen sc1
    buffer_load_dwordx2 v[160:161], v10, s[32:35], s76 offen sc1
    buffer_load_dwordx2 v[162:163], v10, s[32:35], s77 offen sc1
    buffer_load_dwordx2 v[164:165], v10, s[32:35], s78 offen sc1
    buffer_load_dwordx2 v[166:167], v10, s[32:35], s79 offen sc1
    buffer_load_dwordx4 v[24:27], v5, s[32:35], s80 offen sc1
    buffer_load_dwordx4 v[28:31], v5, s[32:35], s81 offen sc1
    buffer_load_dwordx4 v[32:35], v5, s[32:35], s82 offen sc1
    buffer_load_dwordx4 v[36:39], v5, s[32:35], s83 offen sc1
    buffer_load_dwordx4 v[40:43], v5, s[32:35], s84 offen sc1
    buffer_load_dwordx4 v[44:47], v5, s[32:35], s85 offen sc1
    buffer_load_dwordx4 v[48:51], v5, s[32:35], s86 offen sc1
    buffer_load_dwordx4 v[52:55], v5, s[32:35], s87 offen sc1
    s_waitcnt vmcnt(0)
    v_xor_b32 v153, s40, v153
    v_xor_b32 v155, s40, v155
    v_xor_b32 v157, s40, v157
    v_xor_b32 v159, s40, v159
    v_xor_b32 v161, s40, v161
    v_xor_b32 v163, s40, v163
    v_xor_b32 v165, s40, v165
    v_xor_b32 v167, s40, v167
    v_maximum3_f32 v7, v152, v154, v156
    v_maximum3_f32 v8, v158, v160, v162
    v_or3_b32 v9, v153, v155, v157
    v_maximum3_f32 v7, v7, v164, v166
    v_or3_b32 v9, v9, v159, v161
    v_maximum3_f32 v7, v7, v8, v8
    v_or3_b32 v9, v9, v163, v165
    v_or_b32 v9, v9, v167
    v_sub_f32 v16, v152, v7
    v_sub_f32 v17, v154, v7
    v_sub_f32 v18, v156, v7
    v_sub_f32 v19, v158, v7
    v_sub_f32 v20, v160, v7
    v_sub_f32 v21, v162, v7
    v_sub_f32 v22, v164, v7
    v_sub_f32 v23, v166, v7
    v_exp_f32 v16, v16
    v_exp_f32 v17, v17
    v_exp_f32 v18, v18
    v_exp_f32 v19, v19
    v_exp_f32 v20, v20
    v_exp_f32 v21, v21
    v_exp_f32 v22, v22
    v_exp_f32 v23, v23
    v_mov_b32 v8, 0
    v_xor_b32 v24, v24, v224
    v_xor_b32 v25, v25, v225
    v_xor_b32 v26, v26, v226
    v_xor_b32 v27, v27, v227
    v_or3_b32 v8, v8, v24, v25
    v_or3_b32 v8, v8, v26, v27
    v_mfma_f32_16x16x32_bf16 v[168:171], v[12:15], v[24:27], 0
    v_xor_b32 v28, v28, v224
    v_xor_b32 v29, v29, v225
    v_xor_b32 v30, v30, v226
    v_xor_b32 v31, v31, v227
    v_or3_b32 v8, v8, v28, v29
    v_or3_b32 v8, v8, v30, v31
    v_mfma_f32_16x16x32_bf16 v[172:175], v[12:15], v[28:31], 0
    v_xor_b32 v32, v32, v224
    v_xor_b32 v33, v33, v225
    v_xor_b32 v34, v34, v226
    v_xor_b32 v35, v35, v227
    v_or3_b32 v8, v8, v32, v33
    v_or3_b32 v8, v8, v34, v35
    v_mfma_f32_16x16x32_bf16 v[176:179], v[12:15], v[32:35], 0
    v_xor_b32 v36, v36, v224
    v_xor_b32 v37, v37, v225
    v_xor_b32 v38, v38, v226
    v_xor_b32 v39, v39, v227
    v_or3_b32 v8, v8, v36, v37
    v_or3_b32 v8, v8, v38, v39
    v_mfma_f32_16x16x32_bf16 v[180:183], v[12:15], v[36:39], 0
    v_xor_b32 v40, v40, v224
    v_xor_b32 v41, v41, v225
    v_xor_b32 v42, v42, v226
    v_xor_b32 v43, v43, v227
    v_or3_b32 v8, v8, v40, v41
    v_or3_b32 v8, v8, v42, v43
    v_mfma_f32_16x16x32_bf16 v[184:187], v[12:15], v[40:43], 0
    v_xor_b32 v44, v44, v224
    v_xor_b32 v45, v45, v225
    v_xor_b32 v46, v46, v226
    v_xor_b32 v47, v47, v227
    v_or3_b32 v8, v8, v44, v45
    v_or3_b32 v8, v8, v46, v47
    v_mfma_f32_16x16x32_bf16 v[188:191], v[12:15], v[44:47], 0
    v_xor_b32 v48, v48, v224
    v_xor_b32 v49, v49, v225
    v_xor_b32 v50, v50, v226
    v_xor_b32 v51, v51, v227
    v_or3_b32 v8, v8, v48, v49
    v_or3_b32 v8, v8, v50, v51
    v_mfma_f32_16x16x32_bf16 v[192:195], v[12:15], v[48:51], 0
    v_xor_b32 v52, v52, v224
    v_xor_b32 v53, v53, v225
    v_xor_b32 v54, v54, v226
    v_xor_b32 v55, v55, v227
    v_or3_b32 v8, v8, v52, v53
    v_or3_b32 v8, v8, v54, v55
    v_mfma_f32_16x16x32_bf16 v[196:199], v[12:15], v[52:55], 0
    v_and_or_b32 v9, v8, s61, v9
    v_cmp_ne_u32 vcc, 0, v9
    s_cbranch_vccz L_pok
    s_add_u32 s62, s62, 1
    s_cmp_lt_u32 s62, 2097152
    s_cbranch_scc1 L_pload
L_pok:
    s_nop 4
    v_mul_f32 v7, v16, v168
    v_mul_f32 v8, v17, v172
    v_fmac_f32 v7, v18, v176
    v_fmac_f32 v8, v19, v180
    v_fmac_f32 v7, v20, v184
    v_fmac_f32 v8, v21, v188
    v_fmac_f32 v7, v22, v192
    v_fmac_f32 v8, v23, v196
    s_waitcnt vmcnt(21)
    v_mfma_f32_16x16x32_bf16 v[152:155], v[56:59], v[24:27], 0
    v_mfma_f32_16x16x32_bf16 v[156:159], v[60:63], v[24:27], 0
    v_mfma_f32_16x16x32_bf16 v[160:163], v[64:67], v[24:27], 0
    v_add_f32 v7, v7, v8
    v_rcp_f32 v7, v7
    s_waitcnt vmcnt(18)
    v_mfma_f32_16x16x32_bf16 v[168:171], v[68:71], v[28:31], 0
    v_mfma_f32_16x16x32_bf16 v[172:175], v[72:75], v[28:31], 0
    v_mfma_f32_16x16x32_bf16 v[176:179], v[76:79], v[28:31], 0
    v_mul_f32 v16, v16, v7
    v_mul_f32 v17, v17, v7
    v_mul_f32 v18, v18, v7
    v_mul_f32 v19, v19, v7
    v_mul_f32 v20, v20, v7
    v_mul_f32 v21, v21, v7
    v_mul_f32 v22, v22, v7
    v_mul_f32 v23, v23, v7
    s_waitcnt vmcnt(15)
    v_mfma_f32_16x16x32_bf16 v[184:187], v[80:83], v[32:35], 0
    v_mfma_f32_16x16x32_bf16 v[188:191], v[84:87], v[32:35], 0
    v_mfma_f32_16x16x32_bf16 v[192:195], v[88:91], v[32:35], 0
    v_pk_mul_f32 v[200:201], v[152:153], v[16:17] op_sel_hi:[1,0]
    v_pk_mul_f32 v[202:203], v[154:155], v[16:17] op_sel_hi:[1,0]
    v_pk_mul_f32 v[204:205], v[156:157], v[16:17] op_sel_hi:[1,0]
    v_pk_mul_f32 v[206:207], v[158:159], v[16:17] op_sel_hi:[1,0]
    v_pk_mul_f32 v[208:209], v[160:161], v[16:17] op_sel_hi:[1,0]
    v_pk_mul_f32 v[210:211], v[162:163], v[16:17] op_sel_hi:[1,0]
    s_waitcnt vmcnt(12)
    v_mfma_f32_16x16x32_bf16 v[152:155], v[92:95], v[36:39], 0
    v_mfma_f32_16x16x32_bf16 v[156:159], v[96:99], v[36:39], 0
    v_mfma_f32_16x16x32_bf16 v[160:163], v[100:103], v[36:39], 0
    v_pk_fma_f32 v[200:201], v[168:169], v[16:17], v[200:201] op_sel:[0,1,0] op_sel_hi:[1,1,1]
    v_pk_fma_f32 v[202:203], v[170:171], v[16:17], v[202:203] op_sel:[0,1,0] op_sel_hi:[1,1,1]
    v_pk_fma_f32 v[204:205], v[172:173], v[16:17], v[204:205] op_sel:[0,1,0] op_sel_hi:[1,1,1]
    v_pk_fma_f32 v[206:207], v[174:175], v[16:17], v[206:207] op_sel:[0,1,0] op_sel_hi:[1,1,1]
    v_pk_fma_f32 v[208:209], v[176:177], v[16:17], v[208:209] op_sel:[0,1,0] op_sel_hi:[1,1,1]
    v_pk_fma_f32 v[210:211], v[178:179], v[16:17], v[210:211] op_sel:[0,1,0] op_sel_hi:[1,1,1]
    s_waitcnt vmcnt(9)
    v_mfma_f32_16x16x32_bf16 v[168:171], v[104:107], v[40:43], 0
    v_mfma_f32_16x16x32_bf16 v[172:175], v[108:111], v[40:43], 0
    v_mfma_f32_16x16x32_bf16 v[176:179], v[112:115], v[40:43], 0
    v_pk_fma_f32 v[200:201], v[184:185], v[18:19], v[200:201] op_sel_hi:[1,0,1]
    v_pk_fma_f32 v[202:203], v[186:187], v[18:19], v[202:203] op_sel_hi:[1,0,1]
    v_pk_fma_f32 v[204:205], v[188:189], v[18:19], v[204:205] op_sel_hi:[1,0,1]
    v_pk_fma_f32 v[206:207], v[190:191], v[18:19], v[206:207] op_sel_hi:[1,0,1]
    v_pk_fma_f32 v[208:209], v[192:193], v[18:19], v[208:209] op_sel_hi:[1,0,1]
    v_pk_fma_f32 v[210:211], v[194:195], v[18:19], v[210:211] op_sel_hi:[1,0,1]
    s_waitcnt vmcnt(6)
    v_mfma_f32_16x16x32_bf16 v[184:187], v[116:119], v[44:47], 0
    v_mfma_f32_16x16x32_bf16 v[188:191], v[120:123], v[44:47], 0
    v_mfma_f32_16x16x32_bf16 v[192:195], v[124:127], v[44:47], 0
    v_pk_fma_f32 v[200:201], v[152:153], v[18:19], v[200:201] op_sel:[0,1,0] op_sel_hi:[1,1,1]
    v_pk_fma_f32 v[202:203], v[154:155], v[18:19], v[202:203] op_sel:[0,1,0] op_sel_hi:[1,1,1]
    v_pk_fma_f32 v[204:205], v[156:157], v[18:19], v[204:205] op_sel:[0,1,0] op_sel_hi:[1,1,1]
    v_pk_fma_f32 v[206:207], v[158:159], v[18:19], v[206:207] op_sel:[0,1,0] op_sel_hi:[1,1,1]
    v_pk_fma_f32 v[208:209], v[160:161], v[18:19], v[208:209] op_sel:[0,1,0] op_sel_hi:[1,1,1]
    v_pk_fma_f32 v[210:211], v[162:163], v[18:19], v[210:211] op_sel:[0,1,0] op_sel_hi:[1,1,1]
    s_waitcnt vmcnt(3)
    v_mfma_f32_16x16x32_bf16 v[152:155], v[128:131], v[48:51], 0
    v_mfma_f32_16x16x32_bf16 v[156:159], v[132:135], v[48:51], 0
    v_mfma_f32_16x16x32_bf16 v[160:163], v[136:139], v[48:51], 0
    v_mov_b32 v230, 160768
    s_mov_b32 s48, 0
ldsw_56:
    ds_read_b32 v231, v230 offset:48
    s_waitcnt lgkmcnt(0)
    v_readfirstlane_b32 s60, v231
    s_nop 1
    s_cmp_ge_u32 s60, 1
    s_cbranch_scc1 ldsd_57
    s_sleep 1
    s_add_u32 s48, s48, 1
    s_cmp_lt_u32 s48, 2097152
    s_cbranch_scc1 ldsw_56
ldsd_57:
    ds_read_b128 v[232:235], v229 offset:0
    ds_read_b128 v[236:239], v229 offset:64
    ds_read_b128 v[240:243], v229 offset:128
    v_pk_fma_f32 v[200:201], v[168:169], v[20:21], v[200:201] op_sel_hi:[1,0,1]
    v_pk_fma_f32 v[202:203], v[170:171], v[20:21], v[202:203] op_sel_hi:[1,0,1]
    v_pk_fma_f32 v[204:205], v[172:173], v[20:21], v[204:205] op_sel_hi:[1,0,1]
    v_pk_fma_f32 v[206:207], v[174:175], v[20:21], v[206:207] op_sel_hi:[1,0,1]
    v_pk_fma_f32 v[208:209], v[176:177], v[20:21], v[208:209] op_sel_hi:[1,0,1]
    v_pk_fma_f32 v[210:211], v[178:179], v[20:21], v[210:211] op_sel_hi:[1,0,1]
    s_waitcnt vmcnt(0)
    v_mfma_f32_16x16x32_bf16 v[168:171], v[140:143], v[52:55], 0
    v_mfma_f32_16x16x32_bf16 v[172:175], v[144:147], v[52:55], 0
    v_mfma_f32_16x16x32_bf16 v[176:179], v[148:151], v[52:55], 0
    v_pk_fma_f32 v[200:201], v[184:185], v[20:21], v[200:201] op_sel:[0,1,0] op_sel_hi:[1,1,1]
    v_pk_fma_f32 v[202:203], v[186:187], v[20:21], v[202:203] op_sel:[0,1,0] op_sel_hi:[1,1,1]
    v_pk_fma_f32 v[204:205], v[188:189], v[20:21], v[204:205] op_sel:[0,1,0] op_sel_hi:[1,1,1]
    v_pk_fma_f32 v[206:207], v[190:191], v[20:21], v[206:207] op_sel:[0,1,0] op_sel_hi:[1,1,1]
    v_pk_fma_f32 v[208:209], v[192:193], v[20:21], v[208:209] op_sel:[0,1,0] op_sel_hi:[1,1,1]
    v_pk_fma_f32 v[210:211], v[194:195], v[20:21], v[210:211] op_sel:[0,1,0] op_sel_hi:[1,1,1]
    v_pk_fma_f32 v[200:201], v[152:153], v[22:23], v[200:201] op_sel_hi:[1,0,1]
    v_pk_fma_f32 v[202:203], v[154:155], v[22:23], v[202:203] op_sel_hi:[1,0,1]
    v_pk_fma_f32 v[204:205], v[156:157], v[22:23], v[204:205] op_sel_hi:[1,0,1]
    v_pk_fma_f32 v[206:207], v[158:159], v[22:23], v[206:207] op_sel_hi:[1,0,1]
    v_pk_fma_f32 v[208:209], v[160:161], v[22:23], v[208:209] op_sel_hi:[1,0,1]
    v_pk_fma_f32 v[210:211], v[162:163], v[22:23], v[210:211] op_sel_hi:[1,0,1]
    v_pk_fma_f32 v[200:201], v[168:169], v[22:23], v[200:201] op_sel:[0,1,0] op_sel_hi:[1,1,1]
    v_pk_fma_f32 v[202:203], v[170:171], v[22:23], v[202:203] op_sel:[0,1,0] op_sel_hi:[1,1,1]
    v_pk_fma_f32 v[204:205], v[172:173], v[22:23], v[204:205] op_sel:[0,1,0] op_sel_hi:[1,1,1]
    v_pk_fma_f32 v[206:207], v[174:175], v[22:23], v[206:207] op_sel:[0,1,0] op_sel_hi:[1,1,1]
    v_pk_fma_f32 v[208:209], v[176:177], v[22:23], v[208:209] op_sel:[0,1,0] op_sel_hi:[1,1,1]
    v_pk_fma_f32 v[210:211], v[178:179], v[22:23], v[210:211] op_sel:[0,1,0] op_sel_hi:[1,1,1]
    s_waitcnt lgkmcnt(0)
    v_fma_f32 v200, v200, v232, v212
    v_fma_f32 v201, v201, v233, v213
    v_fma_f32 v202, v202, v234, v214
    v_fma_f32 v203, v203, v235, v215
    v_cvt_pk_bf16_f32 v24, v200, v201
    v_cvt_pk_bf16_f32 v25, v202, v203
    buffer_store_dwordx2 v[24:25], v250, s[24:27], s54 offen offset:0
    v_fma_f32 v204, v204, v236, v216
    v_fma_f32 v205, v205, v237, v217
    v_fma_f32 v206, v206, v238, v218
    v_fma_f32 v207, v207, v239, v219
    v_cvt_pk_bf16_f32 v26, v204, v205
    v_cvt_pk_bf16_f32 v27, v206, v207
    buffer_store_dwordx2 v[26:27], v250, s[24:27], s54 offen offset:32
    v_fma_f32 v208, v208, v240, v220
    v_fma_f32 v209, v209, v241, v221
    v_fma_f32 v210, v210, v242, v222
    v_fma_f32 v211, v211, v243, v223
    v_cvt_pk_bf16_f32 v28, v208, v209
    v_cvt_pk_bf16_f32 v29, v210, v211
    buffer_store_dwordx2 v[28:29], v250, s[24:27], s54 offen offset:64
L_fin:
L_end:
    s_endpgm
.section .rodata,"a"
.p2align 6
.amdhsa_kernel standalone__dit_adaln_block__diffusion_kernel
  .amdhsa_next_free_vgpr 256
  .amdhsa_next_free_sgpr 102
  .amdhsa_accum_offset 256
  .amdhsa_group_segment_fixed_size 0
  .amdhsa_kernarg_size 64
  .amdhsa_user_sgpr_count 2
  .amdhsa_user_sgpr_kernarg_segment_ptr 1
  .amdhsa_system_sgpr_workgroup_id_x 1
.end_amdhsa_kernel
```
